```python
import torch

def _softmax(x, axis=-1):
    return torch.softmax(x, dim=axis)

def _gelu(x):
    return torch.nn.functional.gelu(x, approximate='tanh')

def _silu(x):
    return torch.nn.functional.silu(x)

def _sigmoid(x):
    return torch.sigmoid(x)

def _layernorm(x, axis=-1, eps=1e-05):
    m = x.mean(dim=axis, keepdim=True)
    v = x.var(dim=axis, keepdim=True, unbiased=False)
    return (x - m) / torch.sqrt(v + eps)

def _scatter_add(tgt, idx, src, axis=0):
    return tgt.clone().index_add_(axis, idx, src)

def _segment_sum(src, seg, n):
    out = torch.zeros((n,) + src.shape[1:], dtype=src.dtype)
    return out.index_add_(0, seg, src)

def _pad(x, pw):
    flat = tuple((v for pair in reversed(pw) for v in pair))
    return torch.nn.functional.pad(x, flat)
kernel_name = 'adaLN_cond__ssm_conv_s4__glu_gated_glu__prompt'

def setup_inputs():

    _w = lambda a: (lambda t: t.to(torch.bfloat16) if t.is_floating_point() else t)(torch.as_tensor(a))

    def _A_setup():
        B, L, D, N = (1, 2048, 512, 128)
        A_re = -(lambda _x: torch.exp(torch.as_tensor(_x)))((lambda *s: torch.randn(*s, dtype=torch.bfloat16) * 3.2)(D, N))
        A_im = torch.pi * (lambda *s: torch.randn(*s, dtype=torch.bfloat16) * 0.1)(D, N)
        B_re = (lambda *s: torch.randn(*s, dtype=torch.bfloat16) * 0.2)(D, N)
        B_im = (lambda *s: torch.randn(*s, dtype=torch.bfloat16) * 0.2)(D, N)
        C_re = (lambda *s: torch.randn(*s, dtype=torch.bfloat16) * 0.2)(D, N)
        C_im = (lambda *s: torch.randn(*s, dtype=torch.bfloat16) * 0.2)(D, N)
        log_dt = (lambda *s: torch.randn(*s, dtype=torch.bfloat16) * 0.1)(D) * 0.5 - 4.0
        Dskip = (lambda *s: torch.randn(*s, dtype=torch.bfloat16) * 0.1)(D)
        return {'u': _w((lambda *s: torch.randn(*s, dtype=torch.bfloat16) * 0.05)(B, L, D)), 'A_re': _w(A_re), 'A_im': _w(A_im), 'B_re': _w(B_re), 'B_im': _w(B_im), 'C_re': _w(C_re), 'C_im': _w(C_im), 'log_dt': _w(log_dt), 'Dskip': _w(Dskip)}
    _A_in = _A_setup()

    def _B_setup():
        B, S, D, F = (1, 2048, 512, 1792)
        return {'x': _w((lambda *s: torch.randn(*s, dtype=torch.bfloat16) * 0.05)(B, S, D)), 'w_gate': _w((lambda *s: torch.randn(*s, dtype=torch.bfloat16) * 0.05)(D, F)), 'w_up': _w((lambda *s: torch.randn(*s, dtype=torch.bfloat16) * 0.05)(D, F)), 'w_down': _w((lambda *s: torch.randn(*s, dtype=torch.bfloat16) * 0.05)(F, D))}
    _B_in = _B_setup()
    return {'A_u': _A_in['u'], 'A_A_re': _A_in['A_re'], 'A_A_im': _A_in['A_im'], 'A_B_re': _A_in['B_re'], 'A_B_im': _A_in['B_im'], 'A_C_re': _A_in['C_re'], 'A_C_im': _A_in['C_im'], 'A_log_dt': _A_in['log_dt'], 'A_Dskip': _A_in['Dskip'], 'B_x': _B_in['x'], 'B_w_gate': _B_in['w_gate'], 'B_w_up': _B_in['w_up'], 'B_w_down': _B_in['w_down'], 'c': _w((lambda *s: torch.randn(*s, dtype=torch.bfloat16) * 0.1)(1, 512) * 8.0), 'w_mod': _w((lambda *s: torch.randn(*s, dtype=torch.bfloat16) * 0.1)(512, 6 * 512) * 512 ** (-0.5) * 8.0)}

def reference(A_u, A_A_re, A_A_im, A_B_re, A_B_im, A_C_re, A_C_im, A_log_dt, A_Dskip, B_x, B_w_gate, B_w_up, B_w_down, c, w_mod):

    def _A_ref(u, A_re, A_im, B_re, B_im, C_re, C_im, log_dt, Dskip):
        Bsz, L, D = u.shape
        dt = torch.exp(log_dt)[:, None]
        A = A_re + 1j * A_im
        Bc = B_re + 1j * B_im
        Cc = C_re + 1j * C_im
        logdA = dt * A
        dB = dt * Bc
        l = (lambda x, dt: x.to(dt))(torch.arange(L), A_re.dtype)
        P = torch.exp(logdA[:, :, None] * l[None, None, :])
        K = torch.einsum('dn,dnl,dn->dl', Cc, P, dB).real
        L2 = 2 * L
        Kp = _pad(K, ((0, 0), (0, L)))
        up = (lambda x, *d: x.permute(*d))(u, 0, 2, 1)
        up = _pad(up, ((0, 0), (0, 0), (0, L)))
        Kf = (lambda x, axes=(-2, -1): torch.fft.rfft2(x.float(), dim=axes))(Kp[:, None, :], axes=(-2, -1))
        Uf = (lambda x, axes=(-2, -1): torch.fft.rfft2(x.float(), dim=axes))(up[:, :, None, :], axes=(-2, -1))
        Yf = Uf * Kf[None, :, :, :]
        y = (lambda x, s, axes=(-2, -1): torch.fft.irfft2(x, s=s, dim=axes).to(torch.bfloat16))(Yf, (1, L2), axes=(-2, -1))[:, :, 0, :L]
        y = (lambda x, *d: x.permute(*d))(y, 0, 2, 1) + u * Dskip[None, None, :]
        return y

    def _B_ref(x, w_gate, w_up, w_down):
        g = torch.einsum('bsd,df->bsf', x, w_gate)
        u = torch.einsum('bsd,df->bsf', x, w_up)
        h = _sigmoid(g) * u
        return torch.einsum('bsf,fd->bsd', h, w_down)
    x = A_u
    mod = (_silu(c) @ w_mod).reshape(c.shape[0], 6, 1, -1)
    sa, ca, ga, sb, cb, gb = (mod[:, 0].clone(), mod[:, 1].clone(), mod[:, 2].clone(), mod[:, 3].clone(), mod[:, 4].clone(), mod[:, 5].clone())
    h = _layernorm(x, axis=-1) * (1 + ca) + sa
    x = x + ga * _A_ref(h, A_A_re, A_A_im, A_B_re, A_B_im, A_C_re, A_C_im, A_log_dt, A_Dskip)
    h = _layernorm(x, axis=-1) * (1 + cb) + sb
    x = x + gb * _B_ref(h, B_w_gate, B_w_up, B_w_down)
    return x
```

```asm
; @launch grid=(256,1,1) block=(512,1,1) lds=163840
.amdgcn_target "amdgcn-amd-amdhsa--gfx950"
.text
.globl adaLN_cond__ssm_conv_s4__glu_gated_glu__prompt_kernel
.p2align 8
.type adaLN_cond__ssm_conv_s4__glu_gated_glu__prompt_kernel,@function
adaLN_cond__ssm_conv_s4__glu_gated_glu__prompt_kernel:
    s_cmp_ge_u32 s2, 256
    s_cbranch_scc1 L_end
    s_load_dwordx16 s[16:31], s[0:1], 0
    s_load_dwordx16 s[32:47], s[0:1], 64
    s_load_dwordx2 s[4:5], s[0:1], 136
    s_cmp_ge_u32 s2, 16
    s_cbranch_scc1 L_nocpf
    s_getpc_b64 s[54:55]
L_cpf_pc:
    v_lshlrev_b32 v56, 6, v0
    v_min_u32 v56, L_end-L_cpf_pc, v56
    global_load_dword v123, v56, s[54:55]
L_nocpf:
    v_lshrrev_b32 v1, 6, v0
    v_and_b32 v2, 63, v0
    v_readfirstlane_b32 s3, v1
    v_lshlrev_b32 v12, 4, v2
    s_and_b32 s48, s2, 7
    s_lshl_b32 s48, s48, 5
    s_lshr_b32 s49, s2, 3
    s_add_u32 s48, s48, s49
    s_lshl_b32 s48, s48, 1
    s_lshr_b32 s49, s3, 2
    s_add_u32 s48, s48, s49
    s_lshl_b32 s50, s2, 3
    s_add_u32 s50, s50, s3
    s_lshl_b32 s50, s50, 10
    v_add_u32 v5, s50, v12
    s_min_u32 s51, s2, 191
    s_and_b32 s52, s51, 3
    s_lshr_b32 s53, s51, 2
    s_lshl_b32 s54, s52, 7
    s_lshl_b32 s55, s3, 4
    s_add_u32 s54, s54, s55
    v_lshrrev_b32 v3, 3, v2
    v_add_u32 v3, s54, v3
    v_and_b32 v4, 7, v2
    v_mul_u32_u24 v6, 6144, v3
    v_lshl_add_u32 v6, v4, 4, v6
    s_lshl_b32 s54, s53, 7
    v_add_u32 v6, s54, v6
    v_add_u32 v7, 49152, v6
    v_lshlrev_b32 v8, 1, v3
    v_and_b32 v9, 127, v0
    s_lshl_b32 s54, s48, 8
    v_lshl_add_u32 v10, v9, 1, s54
    s_lshl_b32 s54, s48, 1
    v_mov_b32 v11, s54
    v_mov_b32 v28, 0
    v_mov_b32 v29, 0
    v_mov_b32 v30, 0
    v_mov_b32 v31, 0
    v_mov_b32 v32, 0
    v_mov_b32 v33, 0
    v_mov_b32 v34, 0
    v_mov_b32 v35, 0
    v_mov_b32 v36, 0
    s_cmp_lt_u32 s2, 192
    s_cselect_b64 vcc, -1, 0
    v_cndmask_b32 v6, v5, v6, vcc
    v_cndmask_b32 v7, v5, v7, vcc
    s_waitcnt lgkmcnt(0)
    s_cselect_b32 s44, s44, s16
    s_cselect_b32 s45, s45, s17
    global_load_dwordx4 v[16:19], v5, s[16:17] nt
    global_load_short_d16_hi v28, v8, s[42:43]
    global_load_short_d16_hi v29, v8, s[42:43] offset:16
    global_load_dwordx4 v[20:23], v6, s[44:45] nt
    global_load_dwordx4 v[24:27], v7, s[44:45] nt
    s_add_u32 s62, s4, 24117248
    s_addc_u32 s63, s5, 0
    s_load_dword s60, s[62:63], 0
    s_and_b32 s54, s48, -2
    s_lshl_b32 s54, s54, 1
    s_load_dword s59, s[32:33], s54
    s_mov_b64 s[6:7], s[46:47]
    v_mov_b32 v1, 0xffff0000
    v_mov_b32 v14, 0x3f803f80
    s_lshr_b32 s54, s2, 4
    s_and_b32 s55, s2, 15
    s_and_b32 s56, s55, 7
    s_lshl_b32 s56, s56, 6
    s_lshr_b32 s55, s55, 3
    s_add_u32 s56, s56, s55
    s_mul_i32 s56, s56, 3584
    s_mul_i32 s57, s54, 224
    s_add_u32 s56, s56, s57
    s_lshr_b32 s57, s2, 3
    s_mul_i32 s57, s57, 57344
    s_and_b32 s58, s2, 7
    s_lshl_b32 s58, s58, 7
    s_add_u32 s57, s57, s58
    v_min_u32 v56, 447, v0
    v_mul_u32_u24 v57, 4682, v56
    v_lshrrev_b32 v57, 16, v57
    v_mul_u32_u24 v58, 14, v57
    v_sub_u32 v58, v56, v58
    v_mul_u32_u24 v124, 7168, v57
    v_lshl_add_u32 v124, v58, 4, v124
    v_add_u32 v124, s56, v124
    v_and_b32 v59, 3, v57
    v_bfe_u32 v60, v57, 3, 1
    v_lshl_or_b32 v59, v60, 2, v59
    v_xor_b32 v58, v58, v59
    v_lshlrev_b32 v58, 5, v58
    v_lshl_add_u32 v58, v57, 9, v58
    v_add_u32 v126, 127744, v58
    v_lshrrev_b32 v57, 3, v56
    v_and_b32 v58, 7, v56
    v_lshlrev_b32 v125, 10, v57
    v_lshl_add_u32 v125, v58, 4, v125
    v_add_u32 v125, s57, v125
    v_lshlrev_b32 v56, 4, v56
    v_add_u32 v127, 144128, v56
    v_lshrrev_b32 v4, 4, v2
    v_and_b32 v3, 15, v2
    v_and_b32 v13, 255, v0
    v_and_b32 v13, 255, v0
    v_lshlrev_b32 v56, 3, v13
    v_sub_u32 v56, 2047, v56
    v_subrev_u32 v40, 0, v56
    v_max_i32 v40, 0, v40
    v_cvt_f32_u32 v40, v40
    v_subrev_u32 v41, 1, v56
    v_max_i32 v41, 0, v41
    v_cvt_f32_u32 v41, v41
    v_subrev_u32 v42, 2, v56
    v_max_i32 v42, 0, v42
    v_cvt_f32_u32 v42, v42
    v_subrev_u32 v43, 3, v56
    v_max_i32 v43, 0, v43
    v_cvt_f32_u32 v43, v43
    v_subrev_u32 v44, 4, v56
    v_max_i32 v44, 0, v44
    v_cvt_f32_u32 v44, v44
    v_subrev_u32 v45, 5, v56
    v_max_i32 v45, 0, v45
    v_cvt_f32_u32 v45, v45
    v_subrev_u32 v46, 6, v56
    v_max_i32 v46, 0, v46
    v_cvt_f32_u32 v46, v46
    v_subrev_u32 v47, 7, v56
    v_max_i32 v47, 0, v47
    v_cvt_f32_u32 v47, v47
    v_subrev_u32 v48, 8, v56
    v_max_i32 v48, 0, v48
    v_cvt_f32_u32 v48, v48
    v_subrev_u32 v49, 9, v56
    v_max_i32 v49, 0, v49
    v_cvt_f32_u32 v49, v49
    v_subrev_u32 v50, 10, v56
    v_max_i32 v50, 0, v50
    v_cvt_f32_u32 v50, v50
    v_subrev_u32 v51, 11, v56
    v_max_i32 v51, 0, v51
    v_cvt_f32_u32 v51, v51
    v_cvt_pk_bf16_f32 v57, v40, v41
    v_lshlrev_b32 v40, 16, v57
    v_and_b32 v41, v1, v57
    v_cvt_pk_bf16_f32 v57, v42, v43
    v_lshlrev_b32 v42, 16, v57
    v_and_b32 v43, v1, v57
    v_cvt_pk_bf16_f32 v57, v44, v45
    v_lshlrev_b32 v44, 16, v57
    v_and_b32 v45, v1, v57
    v_cvt_pk_bf16_f32 v57, v46, v47
    v_lshlrev_b32 v46, 16, v57
    v_and_b32 v47, v1, v57
    v_cvt_pk_bf16_f32 v57, v48, v49
    v_lshlrev_b32 v48, 16, v57
    v_and_b32 v49, v1, v57
    v_cvt_pk_bf16_f32 v57, v50, v51
    v_lshlrev_b32 v50, 16, v57
    v_and_b32 v51, v1, v57
    s_mul_i32 s54, s49, 7680
    s_add_u32 s54, s54, 69632
    v_cvt_u32_f32 v40, v40
    v_lshrrev_b32 v57, 3, v40
    v_lshl_add_u32 v40, v57, 1, v40
    v_lshl_add_u32 v40, v40, 1, s54
    v_cvt_u32_f32 v41, v41
    v_lshrrev_b32 v57, 3, v41
    v_lshl_add_u32 v41, v57, 1, v41
    v_lshl_add_u32 v41, v41, 1, s54
    v_cvt_u32_f32 v42, v42
    v_lshrrev_b32 v57, 3, v42
    v_lshl_add_u32 v42, v57, 1, v42
    v_lshl_add_u32 v42, v42, 1, s54
    v_cvt_u32_f32 v43, v43
    v_lshrrev_b32 v57, 3, v43
    v_lshl_add_u32 v43, v57, 1, v43
    v_lshl_add_u32 v43, v43, 1, s54
    v_cvt_u32_f32 v44, v44
    v_lshrrev_b32 v57, 3, v44
    v_lshl_add_u32 v44, v57, 1, v44
    v_lshl_add_u32 v44, v44, 1, s54
    v_cvt_u32_f32 v45, v45
    v_lshrrev_b32 v57, 3, v45
    v_lshl_add_u32 v45, v57, 1, v45
    v_lshl_add_u32 v45, v45, 1, s54
    v_cvt_u32_f32 v46, v46
    v_lshrrev_b32 v57, 3, v46
    v_lshl_add_u32 v46, v57, 1, v46
    v_lshl_add_u32 v46, v46, 1, s54
    v_cvt_u32_f32 v47, v47
    v_lshrrev_b32 v57, 3, v47
    v_lshl_add_u32 v47, v57, 1, v47
    v_lshl_add_u32 v47, v47, 1, s54
    v_cvt_u32_f32 v48, v48
    v_lshrrev_b32 v57, 3, v48
    v_lshl_add_u32 v48, v57, 1, v48
    v_lshl_add_u32 v48, v48, 1, s54
    v_cvt_u32_f32 v49, v49
    v_lshrrev_b32 v57, 3, v49
    v_lshl_add_u32 v49, v57, 1, v49
    v_lshl_add_u32 v49, v49, 1, s54
    v_cvt_u32_f32 v50, v50
    v_lshrrev_b32 v57, 3, v50
    v_lshl_add_u32 v50, v57, 1, v50
    v_lshl_add_u32 v50, v50, 1, s54
    v_cvt_u32_f32 v51, v51
    v_lshrrev_b32 v57, 3, v51
    v_lshl_add_u32 v51, v57, 1, v51
    v_lshl_add_u32 v51, v51, 1, s54
    v_lshrrev_b32 v4, 4, v2
    v_and_b32 v3, 15, v2
    s_and_b32 s55, s3, 3
    s_cmp_eq_u32 s55, 1
    s_cbranch_scc1 L_sa1
    s_cmp_eq_u32 s55, 2
    s_cbranch_scc1 L_sa2
    v_and_b32 v56, 1, v4
    v_lshrrev_b32 v57, 1, v4
    v_lshlrev_b32 v56, 2, v56
    v_lshl_add_u32 v56, v57, 7, v56
    v_add_u32 v52, 0, v56
    v_add_u32 v53, 1, v56
    v_add_u32 v54, 2, v56
    v_add_u32 v55, 3, v56
    s_branch L_sa_done
L_sa1:
    v_cmp_gt_u32 vcc, 2, v4
    v_lshlrev_b32 v56, 7, v4
    v_add_u32 v56, 256, v56
    v_lshlrev_b32 v57, 8, v4
    v_cndmask_b32 v56, v57, v56, vcc
    v_mov_b32 v57, 0
    v_mov_b32 v58, 0
    v_cndmask_b32 v57, v57, v58, vcc
    v_add_u32 v52, v56, v57
    v_mov_b32 v57, 4
    v_mov_b32 v58, 2
    v_cndmask_b32 v57, v57, v58, vcc
    v_add_u32 v53, v56, v57
    v_mov_b32 v57, 128
    v_mov_b32 v58, 4
    v_cndmask_b32 v57, v57, v58, vcc
    v_add_u32 v54, v56, v57
    v_mov_b32 v57, 132
    v_mov_b32 v58, 6
    v_cndmask_b32 v57, v57, v58, vcc
    v_add_u32 v55, v56, v57
    s_branch L_sa_done
L_sa2:
    v_lshlrev_b32 v56, 9, v4
    v_add_u32 v56, 1024, v56
    v_add_u32 v52, 0, v56
    v_add_u32 v53, 128, v56
    v_add_u32 v54, 256, v56
    v_add_u32 v55, 384, v56
L_sa_done:
    v_mul_u32_u24 v56, 20, v3
    v_add_u32 v56, s54, v56
    v_lshrrev_b32 v57, 3, v52
    v_lshl_add_u32 v52, v57, 1, v52
    v_lshl_add_u32 v52, v52, 1, v56
    v_lshrrev_b32 v57, 3, v53
    v_lshl_add_u32 v53, v57, 1, v53
    v_lshl_add_u32 v53, v53, 1, v56
    v_lshrrev_b32 v57, 3, v54
    v_lshl_add_u32 v54, v57, 1, v54
    v_lshl_add_u32 v54, v54, 1, v56
    v_lshrrev_b32 v57, 3, v55
    v_lshl_add_u32 v55, v57, 1, v55
    v_lshl_add_u32 v55, v55, 1, v56
    global_load_short_d16_hi v36, v11, s[30:31]
    global_load_short_d16_hi v30, v10, s[18:19] nt
    global_load_short_d16_hi v31, v10, s[20:21] nt
    global_load_short_d16_hi v32, v10, s[22:23] nt
    global_load_short_d16_hi v33, v10, s[24:25] nt
    global_load_short_d16_hi v34, v10, s[26:27] nt
    global_load_short_d16_hi v35, v10, s[28:29] nt
    s_waitcnt vmcnt(11)
    v_dot2_f32_bf16 v56, v16, v14, 0
    v_dot2_f32_bf16 v57, v16, v16, 0
    v_dot2_f32_bf16 v56, v17, v14, v56
    v_dot2_f32_bf16 v57, v17, v17, v57
    v_dot2_f32_bf16 v56, v18, v14, v56
    v_dot2_f32_bf16 v57, v18, v18, v57
    v_dot2_f32_bf16 v56, v19, v14, v56
    v_dot2_f32_bf16 v57, v19, v19, v57
    v_lshlrev_b32 v60, 16, v16
    v_and_b32 v61, v1, v16
    v_lshlrev_b32 v62, 16, v17
    v_and_b32 v63, v1, v17
    v_lshlrev_b32 v64, 16, v18
    v_and_b32 v65, v1, v18
    v_lshlrev_b32 v66, 16, v19
    v_and_b32 v67, v1, v19
    v_permlane32_swap_b32 v56, v57
    v_add_f32 v56, v56, v57
    v_mov_b32 v57, v56
    s_nop 1
    v_permlane16_swap_b32 v56, v57
    v_add_f32 v56, v56, v57
    s_nop 1
    v_add_f32_dpp v56, v56, v56 row_ror:8 row_mask:0xf bank_mask:0xf
    s_nop 1
    v_add_f32_dpp v56, v56, v56 row_ror:4 row_mask:0xf bank_mask:0xf
    s_nop 1
    v_add_f32_dpp v56, v56, v56 row_ror:2 row_mask:0xf bank_mask:0xf
    s_nop 1
    v_add_f32_dpp v56, v56, v56 row_ror:1 row_mask:0xf bank_mask:0xf
    v_mul_f32 v56, 0x3b000000, v56
    v_mov_b32 v57, v56
    s_nop 1
    v_permlane32_swap_b32 v56, v57
    v_fma_f32 v57, -v56, v56, v57
    v_max_f32 v57, 0, v57
    v_cvt_pk_bf16_f32 v58, v57, v56
    v_and_b32 v56, v1, v58
    v_lshlrev_b32 v57, 16, v58
    v_add_f32 v57, 0x3727c5ac, v57
    v_cvt_pk_bf16_f32 v58, v57, v57
    v_and_b32 v57, v1, v58
    v_sqrt_f32 v57, v57
    s_nop 0
    v_cvt_pk_bf16_f32 v58, v57, v57
    v_and_b32 v57, v1, v58
    v_rcp_f32 v57, v57
    v_sub_f32 v60, v60, v56
    v_sub_f32 v61, v61, v56
    v_sub_f32 v62, v62, v56
    v_sub_f32 v63, v63, v56
    v_sub_f32 v64, v64, v56
    v_sub_f32 v65, v65, v56
    v_sub_f32 v66, v66, v56
    v_sub_f32 v67, v67, v56
    v_cvt_pk_bf16_f32 v68, v60, v61
    v_cvt_pk_bf16_f32 v69, v62, v63
    v_cvt_pk_bf16_f32 v70, v64, v65
    v_cvt_pk_bf16_f32 v71, v66, v67
    v_lshlrev_b32 v60, 16, v68
    v_and_b32 v61, v1, v68
    v_lshlrev_b32 v62, 16, v69
    v_and_b32 v63, v1, v69
    v_lshlrev_b32 v64, 16, v70
    v_and_b32 v65, v1, v70
    v_lshlrev_b32 v66, 16, v71
    v_and_b32 v67, v1, v71
    v_mul_f32 v60, v60, v57
    v_mul_f32 v61, v61, v57
    v_mul_f32 v62, v62, v57
    v_mul_f32 v63, v63, v57
    v_mul_f32 v64, v64, v57
    v_mul_f32 v65, v65, v57
    v_mul_f32 v66, v66, v57
    v_mul_f32 v67, v67, v57
    v_cvt_pk_bf16_f32 v68, v60, v61
    v_cvt_pk_bf16_f32 v69, v62, v63
    v_cvt_pk_bf16_f32 v70, v64, v65
    v_cvt_pk_bf16_f32 v71, v66, v67
    s_mul_i32 s56, s3, 1088
    s_add_u32 s56, s56, 127744
    v_add_u32 v5, s56, v12
    ds_write_b128 v5, v[68:71]
    ds_write_b128 v5, v[16:19] offset:8704
    s_mov_b32 s54, 0xbfb8aa3b
    s_waitcnt vmcnt(9)
    v_mul_f32 v56, s54, v28
    v_mul_f32 v57, s54, v29
    v_exp_f32 v56, v56
    v_exp_f32 v57, v57
    v_add_f32 v56, 1.0, v56
    v_add_f32 v57, 1.0, v57
    v_rcp_f32 v56, v56
    v_rcp_f32 v57, v57
    v_mul_f32 v56, v56, v28
    v_mul_f32 v57, v57, v29
    v_cvt_pk_bf16_f32 v58, v56, v57
    v_lshlrev_b32 v28, 16, v58
    v_and_b32 v29, v1, v58
    s_waitcnt vmcnt(8)
    v_lshlrev_b32 v60, 16, v20
    v_and_b32 v61, v1, v20
    v_lshlrev_b32 v62, 16, v21
    v_and_b32 v63, v1, v21
    v_lshlrev_b32 v64, 16, v22
    v_and_b32 v65, v1, v22
    v_lshlrev_b32 v66, 16, v23
    v_and_b32 v67, v1, v23
    v_mul_f32 v72, v60, v28
    v_mul_f32 v73, v61, v28
    v_mul_f32 v74, v62, v28
    v_mul_f32 v75, v63, v28
    v_mul_f32 v76, v64, v28
    v_mul_f32 v77, v65, v28
    v_mul_f32 v78, v66, v28
    v_mul_f32 v79, v67, v28
    s_waitcnt vmcnt(7)
    v_lshlrev_b32 v60, 16, v24
    v_and_b32 v61, v1, v24
    v_lshlrev_b32 v62, 16, v25
    v_and_b32 v63, v1, v25
    v_lshlrev_b32 v64, 16, v26
    v_and_b32 v65, v1, v26
    v_lshlrev_b32 v66, 16, v27
    v_and_b32 v67, v1, v27
    v_fmac_f32 v72, v60, v29
    v_fmac_f32 v73, v61, v29
    v_fmac_f32 v74, v62, v29
    v_fmac_f32 v75, v63, v29
    v_fmac_f32 v76, v64, v29
    v_fmac_f32 v77, v65, v29
    v_fmac_f32 v78, v66, v29
    v_fmac_f32 v79, v67, v29
    v_permlane32_swap_b32 v72, v76
    v_permlane32_swap_b32 v73, v77
    v_permlane32_swap_b32 v74, v78
    v_permlane32_swap_b32 v75, v79
    v_add_f32 v72, v72, v76
    v_add_f32 v73, v73, v77
    v_add_f32 v74, v74, v78
    v_add_f32 v75, v75, v79
    s_nop 0
    v_permlane16_swap_b32 v72, v74
    v_permlane16_swap_b32 v73, v75
    v_add_f32 v72, v72, v74
    v_add_f32 v73, v73, v75
    s_nop 0
    v_add_f32_dpp v72, v72, v72 row_ror:8 row_mask:0xf bank_mask:0xf
    v_add_f32_dpp v73, v73, v73 row_ror:8 row_mask:0xf bank_mask:0xf
    v_and_b32 v56, 7, v2
    v_lshlrev_b32 v56, 5, v56
    v_lshl_add_u32 v56, v4, 3, v56
    s_lshl_b32 s54, s3, 8
    s_add_u32 s54, s54, 145152
    v_add_u32 v56, s54, v56
    ds_write_b64 v56, v[72:73]
    s_mov_b32 s34, s52
    s_mov_b32 s35, s53
    s_waitcnt vmcnt(0)
    global_load_dwordx4 v[88:91], v125, s[40:41] nt
    s_waitcnt lgkmcnt(0)
    s_add_u32 s62, s60, 1
    s_mul_i32 s60, s62, 0x9e3779b1
    s_xor_b32 s60, s60, 0x6a09e667
    v_mov_b32 v15, s60
    s_barrier
    s_cmp_ge_u32 s3, 4
    s_cbranch_scc1 L_kmm
    v_bfe_u32 v56, v2, 2, 2
    v_mul_u32_u24 v56, 1088, v56
    v_and_b32 v57, 3, v2
    v_lshl_add_u32 v56, v57, 3, v56
    v_lshl_add_u32 v56, v4, 5, v56
    s_lshl_b32 s54, s3, 8
    s_add_u32 s54, s54, 127744
    v_add_u32 v56, s54, v56
    v_lshlrev_b32 v57, 2, v2
    v_add_u32 v58, 145152, v57
    ds_read_b64_tr_b16 v[60:61], v56 offset:0
    ds_read_b64_tr_b16 v[62:63], v56 offset:4352
    ds_read_b64_tr_b16 v[64:65], v56 offset:128
    ds_read_b64_tr_b16 v[66:67], v56 offset:4480
    ds_read_b64_tr_b16 v[68:69], v56 offset:8704
    ds_read_b64_tr_b16 v[70:71], v56 offset:13056
    ds_read_b64_tr_b16 v[72:73], v56 offset:8832
    ds_read_b64_tr_b16 v[74:75], v56 offset:13184
    ds_read_b32 v100, v58 offset:0
    ds_read_b32 v101, v58 offset:256
    ds_read_b32 v102, v58 offset:512
    ds_read_b32 v103, v58 offset:768
    ds_read_b32 v104, v58 offset:1024
    ds_read_b32 v105, v58 offset:1280
    ds_read_b32 v106, v58 offset:1536
    ds_read_b32 v107, v58 offset:1792
    s_mul_i32 s54, s2, 8320
    s_lshl_b32 s55, s3, 11
    s_add_u32 s54, s54, s55
    s_add_u32 s54, s54, 3670016
    v_add_u32 v59, s54, v12
    v_add_u32 v99, 2359296, v59
    s_waitcnt lgkmcnt(14)
    global_store_dwordx4 v59, v[60:63], s[4:5] offset:0 sc1
    s_waitcnt lgkmcnt(12)
    global_store_dwordx4 v59, v[64:67], s[4:5] offset:1024 sc1
    s_waitcnt lgkmcnt(10)
    global_store_dwordx4 v99, v[68:71], s[4:5] offset:0 sc1
    s_waitcnt lgkmcnt(8)
    global_store_dwordx4 v99, v[72:75], s[4:5] offset:1024 sc1
    s_cmp_lg_u32 s3, 0
    s_cbranch_scc1 L_kmm
    s_cmp_ge_u32 s2, 192
    s_cbranch_scc1 L_kmm
    s_mul_i32 s54, s34, 12288
    s_lshl_b32 s55, s35, 8
    s_add_u32 s54, s54, s55
    s_add_u32 s54, s54, 23724032
    v_add_u32 v57, s54, v57
    s_waitcnt lgkmcnt(0)
    v_add_f32 v100, v100, v101
    v_add_f32 v102, v102, v103
    v_add_f32 v104, v104, v105
    v_add_f32 v106, v106, v107
    v_add_f32 v100, v100, v102
    v_add_f32 v104, v104, v106
    v_add_f32 v100, v100, v104
    global_store_dword v57, v100, s[4:5] sc1
L_kmm:
    s_waitcnt lgkmcnt(0)
    s_mul_i32 s52, s49, 16640
    s_add_u32 s52, s52, 85248
    s_mul_i32 s53, s49, 4608
    s_add_u32 s53, s53, 118528
    v_lshrrev_b32 v6, 1, v2
    s_lshl_b32 s54, s3, 5
    v_add_u32 v6, s54, v6
    v_and_b32 v23, 1, v2
    v_mul_u32_u24 v10, 4608, v23
    v_lshl_add_u32 v10, v6, 4, v10
    v_add_u32 v10, 119040, v10
    v_lshlrev_b32 v37, 12, v23
    v_lshl_add_u32 v37, v6, 4, v37
    v_add_u32 v37, 65536, v37
    v_mul_u32_u24 v6, 8320, v6
    v_lshl_add_u32 v6, v23, 4, v6
    s_and_b32 s54, s48, -2
    s_lshl_b32 s55, s54, 4
    s_add_u32 s55, s55, 3670016
    v_add_u32 v6, s55, v6
    v_and_b32 v22, 3, v2
    v_mul_u32_u24 v20, 12288, v22
    v_lshrrev_b32 v21, 2, v3
    v_lshl_add_u32 v20, v21, 11, v20
    v_and_b32 v21, 1, v4
    v_lshl_add_u32 v20, v21, 2, v20
    s_lshl_b32 s54, s54, 2
    s_add_u32 s54, s54, 23724032
    v_add_u32 v20, s54, v20
    v_lshrrev_b32 v21, 5, v2
    v_lshlrev_b32 v21, 11, v21
    v_and_b32 v22, 31, v2
    v_lshl_add_u32 v21, v22, 3, v21
    s_and_b32 s54, s2, 7
    s_lshl_b32 s54, s54, 8
    s_bfe_u32 s55, s2, 0x10003
    s_lshl_b32 s55, s55, 2
    s_add_u32 s54, s54, s55
    s_add_u32 s54, s54, 23730176
    v_add_u32 v21, s54, v21
L_noab2:
    s_mul_i32 s54, s49, 34816
    v_lshl_add_u32 v9, v9, 2, s54
    v_mad_u32_u24 v11, v3, 34, v4
    v_lshl_add_u32 v11, v11, 4, s54
    s_mov_b32 s54, 1069066811
    s_mov_b32 s55, 1042479491
    v_mul_f32 v36, s54, v36
    v_exp_f32 v36, v36
    s_nop 0
    v_cvt_pk_bf16_f32 v36, v36, v36
    v_and_b32 v36, v1, v36
    v_mul_f32 v30, v30, v36
    v_mul_f32 v31, v31, v36
    v_mul_f32 v32, v32, v36
    v_mul_f32 v33, v33, v36
    v_mul_f32 v30, s54, v30
    v_mul_f32 v31, s55, v31
    v_pk_mul_f32 v[58:59], v[34:35], v[32:33] op_sel:[1,1] op_sel_hi:[1,0]
    v_pk_fma_f32 v[56:57], v[34:35], v[32:33], v[58:59] op_sel_hi:[0,1,1] neg_lo:[0,0,1]
    s_bitcmp1_b32 s3, 1
    s_cbranch_scc1 L_halfB
    v_mul_f32 v58, 1.0, v30
    v_mul_f32 v59, 1.0, v31
    v_exp_f32 v58, v58
    v_fract_f32 v59, v59
    v_cos_f32 v110, v59
    v_sin_f32 v111, v59
    v_mul_f32 v110, v110, v58
    v_mul_f32 v111, v111, v58
    v_mul_f32 v58, 0x43000000, v30
    v_mul_f32 v59, 0x43000000, v31
    v_exp_f32 v58, v58
    v_fract_f32 v59, v59
    v_cos_f32 v66, v59
    v_sin_f32 v67, v59
    v_mul_f32 v66, v66, v58
    v_mul_f32 v67, v67, v58
    v_pk_mul_f32 v[58:59], v[110:111], v[110:111] op_sel:[1,1] op_sel_hi:[1,0]
    v_pk_fma_f32 v[112:113], v[110:111], v[110:111], v[58:59] op_sel_hi:[0,1,1] neg_lo:[0,0,1]
    v_pk_mul_f32 v[60:61], v[56:57], v[66:67] op_sel:[1,1] op_sel_hi:[1,0]
    v_pk_fma_f32 v[70:71], v[56:57], v[66:67], v[60:61] op_sel_hi:[0,1,1] neg_lo:[0,0,1]
    v_pk_mul_f32 v[58:59], v[112:113], v[110:111] op_sel:[1,1] op_sel_hi:[1,0]
    v_pk_fma_f32 v[114:115], v[112:113], v[110:111], v[58:59] op_sel_hi:[0,1,1] neg_lo:[0,0,1]
    v_pk_mul_f32 v[60:61], v[112:113], v[112:113] op_sel:[1,1] op_sel_hi:[1,0]
    v_pk_fma_f32 v[116:117], v[112:113], v[112:113], v[60:61] op_sel_hi:[0,1,1] neg_lo:[0,0,1]
    v_pk_mul_f32 v[58:59], v[70:71], v[66:67] op_sel:[1,1] op_sel_hi:[1,0]
    v_pk_fma_f32 v[72:73], v[70:71], v[66:67], v[58:59] op_sel_hi:[0,1,1] neg_lo:[0,0,1]
    v_pk_mul_f32 v[60:61], v[116:117], v[110:111] op_sel:[1,1] op_sel_hi:[1,0]
    v_pk_fma_f32 v[118:119], v[116:117], v[110:111], v[60:61] op_sel_hi:[0,1,1] neg_lo:[0,0,1]
    v_pk_mul_f32 v[58:59], v[116:117], v[112:113] op_sel:[1,1] op_sel_hi:[1,0]
    v_pk_fma_f32 v[120:121], v[116:117], v[112:113], v[58:59] op_sel_hi:[0,1,1] neg_lo:[0,0,1]
    v_pk_mul_f32 v[60:61], v[116:117], v[114:115] op_sel:[1,1] op_sel_hi:[1,0]
    v_pk_fma_f32 v[122:123], v[116:117], v[114:115], v[60:61] op_sel_hi:[0,1,1] neg_lo:[0,0,1]
    v_pk_mul_f32 v[58:59], v[72:73], v[66:67] op_sel:[1,1] op_sel_hi:[1,0]
    v_pk_fma_f32 v[74:75], v[72:73], v[66:67], v[58:59] op_sel_hi:[0,1,1] neg_lo:[0,0,1]
    s_waitcnt vmcnt(0)
    s_barrier
    ds_write_b128 v127, v[88:91]
    s_cmp_lg_u32 s3, 3
    s_cbranch_scc1 L_nosig1a
    s_lshl_b32 s54, s2, 7
    s_add_u32 s54, s54, 24150016
    v_lshl_add_u32 v96, v2, 2, s54
    s_mov_b64 exec, 0xffffffff
    global_store_dword v96, v15, s[4:5] sc1
    s_mov_b64 exec, -1
L_nosig1a:
    s_cmp_eq_u32 s3, 7
    s_cbranch_scc1 L_adaLN_cond__ssm_conv_s4__glu_gated_glu__prompt_kernel_now1
    global_load_dwordx4 v[80:83], v124, s[36:37] nt
    global_load_dwordx4 v[84:87], v124, s[38:39] nt
L_adaLN_cond__ssm_conv_s4__glu_gated_glu__prompt_kernel_now1:
    v_cvt_pk_bf16_f32 v62, v56, v57
    ds_write_b32 v9, v62 offset:0
    v_pk_mul_f32 v[60:61], v[56:57], v[110:111] op_sel:[1,1] op_sel_hi:[1,0]
    v_pk_fma_f32 v[78:79], v[56:57], v[110:111], v[60:61] op_sel_hi:[0,1,1] neg_lo:[0,0,1]
    v_cvt_pk_bf16_f32 v63, v78, v79
    ds_write_b32 v9, v63 offset:544
    v_pk_mul_f32 v[58:59], v[56:57], v[112:113] op_sel:[1,1] op_sel_hi:[1,0]
    v_pk_fma_f32 v[76:77], v[56:57], v[112:113], v[58:59] op_sel_hi:[0,1,1] neg_lo:[0,0,1]
    v_cvt_pk_bf16_f32 v64, v76, v77
    ds_write_b32 v9, v64 offset:1088
    v_pk_mul_f32 v[60:61], v[56:57], v[114:115] op_sel:[1,1] op_sel_hi:[1,0]
    v_pk_fma_f32 v[78:79], v[56:57], v[114:115], v[60:61] op_sel_hi:[0,1,1] neg_lo:[0,0,1]
    v_cvt_pk_bf16_f32 v65, v78, v79
    ds_write_b32 v9, v65 offset:1632
    v_pk_mul_f32 v[58:59], v[56:57], v[116:117] op_sel:[1,1] op_sel_hi:[1,0]
    v_pk_fma_f32 v[76:77], v[56:57], v[116:117], v[58:59] op_sel_hi:[0,1,1] neg_lo:[0,0,1]
    v_cvt_pk_bf16_f32 v62, v76, v77
    ds_write_b32 v9, v62 offset:2176
    v_pk_mul_f32 v[60:61], v[56:57], v[118:119] op_sel:[1,1] op_sel_hi:[1,0]
    v_pk_fma_f32 v[78:79], v[56:57], v[118:119], v[60:61] op_sel_hi:[0,1,1] neg_lo:[0,0,1]
    v_cvt_pk_bf16_f32 v63, v78, v79
    ds_write_b32 v9, v63 offset:2720
    v_pk_mul_f32 v[58:59], v[56:57], v[120:121] op_sel:[1,1] op_sel_hi:[1,0]
    v_pk_fma_f32 v[76:77], v[56:57], v[120:121], v[58:59] op_sel_hi:[0,1,1] neg_lo:[0,0,1]
    v_cvt_pk_bf16_f32 v64, v76, v77
    ds_write_b32 v9, v64 offset:3264
    v_pk_mul_f32 v[60:61], v[56:57], v[122:123] op_sel:[1,1] op_sel_hi:[1,0]
    v_pk_fma_f32 v[78:79], v[56:57], v[122:123], v[60:61] op_sel_hi:[0,1,1] neg_lo:[0,0,1]
    v_cvt_pk_bf16_f32 v65, v78, v79
    ds_write_b32 v9, v65 offset:3808
    v_cvt_pk_bf16_f32 v62, v70, v71
    ds_write_b32 v9, v62 offset:4352
    v_pk_mul_f32 v[60:61], v[70:71], v[110:111] op_sel:[1,1] op_sel_hi:[1,0]
    v_pk_fma_f32 v[78:79], v[70:71], v[110:111], v[60:61] op_sel_hi:[0,1,1] neg_lo:[0,0,1]
    v_cvt_pk_bf16_f32 v63, v78, v79
    ds_write_b32 v9, v63 offset:4896
    v_pk_mul_f32 v[58:59], v[70:71], v[112:113] op_sel:[1,1] op_sel_hi:[1,0]
    v_pk_fma_f32 v[76:77], v[70:71], v[112:113], v[58:59] op_sel_hi:[0,1,1] neg_lo:[0,0,1]
    v_cvt_pk_bf16_f32 v64, v76, v77
    ds_write_b32 v9, v64 offset:5440
    v_pk_mul_f32 v[60:61], v[70:71], v[114:115] op_sel:[1,1] op_sel_hi:[1,0]
    v_pk_fma_f32 v[78:79], v[70:71], v[114:115], v[60:61] op_sel_hi:[0,1,1] neg_lo:[0,0,1]
    v_cvt_pk_bf16_f32 v65, v78, v79
    ds_write_b32 v9, v65 offset:5984
    v_pk_mul_f32 v[58:59], v[70:71], v[116:117] op_sel:[1,1] op_sel_hi:[1,0]
    v_pk_fma_f32 v[76:77], v[70:71], v[116:117], v[58:59] op_sel_hi:[0,1,1] neg_lo:[0,0,1]
    v_cvt_pk_bf16_f32 v62, v76, v77
    ds_write_b32 v9, v62 offset:6528
    v_pk_mul_f32 v[60:61], v[70:71], v[118:119] op_sel:[1,1] op_sel_hi:[1,0]
    v_pk_fma_f32 v[78:79], v[70:71], v[118:119], v[60:61] op_sel_hi:[0,1,1] neg_lo:[0,0,1]
    v_cvt_pk_bf16_f32 v63, v78, v79
    ds_write_b32 v9, v63 offset:7072
    v_pk_mul_f32 v[58:59], v[70:71], v[120:121] op_sel:[1,1] op_sel_hi:[1,0]
    v_pk_fma_f32 v[76:77], v[70:71], v[120:121], v[58:59] op_sel_hi:[0,1,1] neg_lo:[0,0,1]
    v_cvt_pk_bf16_f32 v64, v76, v77
    ds_write_b32 v9, v64 offset:7616
    v_pk_mul_f32 v[60:61], v[70:71], v[122:123] op_sel:[1,1] op_sel_hi:[1,0]
    v_pk_fma_f32 v[78:79], v[70:71], v[122:123], v[60:61] op_sel_hi:[0,1,1] neg_lo:[0,0,1]
    v_cvt_pk_bf16_f32 v65, v78, v79
    ds_write_b32 v9, v65 offset:8160
    v_cvt_pk_bf16_f32 v62, v72, v73
    ds_write_b32 v9, v62 offset:8704
    v_pk_mul_f32 v[60:61], v[72:73], v[112:113] op_sel:[1,1] op_sel_hi:[1,0]
    v_pk_fma_f32 v[78:79], v[72:73], v[112:113], v[60:61] op_sel_hi:[0,1,1] neg_lo:[0,0,1]
    v_cvt_pk_bf16_f32 v63, v78, v79
    ds_write_b32 v9, v63 offset:9248
    v_pk_mul_f32 v[58:59], v[72:73], v[116:117] op_sel:[1,1] op_sel_hi:[1,0]
    v_pk_fma_f32 v[76:77], v[72:73], v[116:117], v[58:59] op_sel_hi:[0,1,1] neg_lo:[0,0,1]
    v_cvt_pk_bf16_f32 v64, v76, v77
    ds_write_b32 v9, v64 offset:9792
    v_pk_mul_f32 v[60:61], v[72:73], v[120:121] op_sel:[1,1] op_sel_hi:[1,0]
    v_pk_fma_f32 v[78:79], v[72:73], v[120:121], v[60:61] op_sel_hi:[0,1,1] neg_lo:[0,0,1]
    v_cvt_pk_bf16_f32 v65, v78, v79
    ds_write_b32 v9, v65 offset:10336
    v_cvt_pk_bf16_f32 v62, v74, v75
    ds_write_b32 v9, v62 offset:10880
    v_pk_mul_f32 v[60:61], v[74:75], v[112:113] op_sel:[1,1] op_sel_hi:[1,0]
    v_pk_fma_f32 v[78:79], v[74:75], v[112:113], v[60:61] op_sel_hi:[0,1,1] neg_lo:[0,0,1]
    v_cvt_pk_bf16_f32 v63, v78, v79
    ds_write_b32 v9, v63 offset:11424
    v_pk_mul_f32 v[58:59], v[74:75], v[116:117] op_sel:[1,1] op_sel_hi:[1,0]
    v_pk_fma_f32 v[76:77], v[74:75], v[116:117], v[58:59] op_sel_hi:[0,1,1] neg_lo:[0,0,1]
    v_cvt_pk_bf16_f32 v64, v76, v77
    ds_write_b32 v9, v64 offset:11968
    v_pk_mul_f32 v[60:61], v[74:75], v[120:121] op_sel:[1,1] op_sel_hi:[1,0]
    v_pk_fma_f32 v[78:79], v[74:75], v[120:121], v[60:61] op_sel_hi:[0,1,1] neg_lo:[0,0,1]
    v_cvt_pk_bf16_f32 v65, v78, v79
    ds_write_b32 v9, v65 offset:12512
    s_branch L_uv_done
L_halfB:
    v_mul_f32 v58, 0x41000000, v30
    v_mul_f32 v59, 0x41000000, v31
    v_exp_f32 v58, v58
    v_fract_f32 v59, v59
    v_cos_f32 v112, v59
    v_sin_f32 v113, v59
    v_mul_f32 v112, v112, v58
    v_mul_f32 v113, v113, v58
    v_mul_f32 v58, 0x43000000, v30
    v_mul_f32 v59, 0x43000000, v31
    v_exp_f32 v58, v58
    v_fract_f32 v59, v59
    v_cos_f32 v66, v59
    v_sin_f32 v67, v59
    v_mul_f32 v66, v66, v58
    v_mul_f32 v67, v67, v58
    v_mul_f32 v58, 0x44000000, v30
    v_mul_f32 v59, 0x44000000, v31
    v_exp_f32 v58, v58
    v_fract_f32 v59, v59
    v_cos_f32 v114, v59
    v_sin_f32 v115, v59
    v_mul_f32 v114, v114, v58
    v_mul_f32 v115, v115, v58
    v_mul_f32 v58, 4.0, v30
    v_mul_f32 v59, 4.0, v31
    v_exp_f32 v58, v58
    v_fract_f32 v59, v59
    v_cos_f32 v110, v59
    v_sin_f32 v111, v59
    v_mul_f32 v110, v110, v58
    v_mul_f32 v111, v111, v58
    v_mov_b32 v116, 1.0
    v_mov_b32 v117, 0
    v_cvt_pk_bf16_f32 v62, v116, -v117
    ds_write_b32 v9, v62 offset:26112
    v_cvt_pk_bf16_f32 v63, v112, -v113
    ds_write_b32 v9, v63 offset:26656
    v_pk_mul_f32 v[58:59], v[56:57], v[114:115] op_sel:[1,1] op_sel_hi:[1,0]
    v_pk_fma_f32 v[120:121], v[56:57], v[114:115], v[58:59] op_sel_hi:[0,1,1] neg_lo:[0,0,1]
    v_pk_mul_f32 v[58:59], v[112:113], v[112:113] op_sel:[1,1] op_sel_hi:[1,0]
    v_pk_fma_f32 v[116:117], v[112:113], v[112:113], v[58:59] op_sel_hi:[0,1,1] neg_lo:[0,0,1]
    v_cvt_pk_bf16_f32 v64, v116, -v117
    ds_write_b32 v9, v64 offset:27200
    v_cvt_pk_bf16_f32 v65, v120, v121
    ds_write_b32 v9, v65 offset:13056
    v_pk_mul_f32 v[60:61], v[120:121], v[110:111] op_sel:[1,1] op_sel_hi:[1,0]
    v_pk_fma_f32 v[76:77], v[120:121], v[110:111], v[60:61] op_sel_hi:[0,1,1] neg_lo:[0,0,1]
    v_cvt_pk_bf16_f32 v62, v76, v77
    ds_write_b32 v9, v62 offset:13600
    v_pk_mul_f32 v[60:61], v[120:121], v[66:67] op_sel:[1,1] op_sel_hi:[1,0]
    v_pk_fma_f32 v[122:123], v[120:121], v[66:67], v[60:61] op_sel_hi:[0,1,1] neg_lo:[0,0,1]
    v_pk_mul_f32 v[58:59], v[116:117], v[112:113] op_sel:[1,1] op_sel_hi:[1,0]
    v_pk_fma_f32 v[118:119], v[116:117], v[112:113], v[58:59] op_sel_hi:[0,1,1] neg_lo:[0,0,1]
    v_cvt_pk_bf16_f32 v63, v118, -v119
    ds_write_b32 v9, v63 offset:27744
    v_cvt_pk_bf16_f32 v64, v122, v123
    ds_write_b32 v9, v64 offset:14144
    v_pk_mul_f32 v[60:61], v[122:123], v[110:111] op_sel:[1,1] op_sel_hi:[1,0]
    v_pk_fma_f32 v[76:77], v[122:123], v[110:111], v[60:61] op_sel_hi:[0,1,1] neg_lo:[0,0,1]
    v_cvt_pk_bf16_f32 v65, v76, v77
    ds_write_b32 v9, v65 offset:14688
    v_pk_mul_f32 v[60:61], v[122:123], v[66:67] op_sel:[1,1] op_sel_hi:[1,0]
    v_pk_fma_f32 v[120:121], v[122:123], v[66:67], v[60:61] op_sel_hi:[0,1,1] neg_lo:[0,0,1]
    v_pk_mul_f32 v[58:59], v[118:119], v[112:113] op_sel:[1,1] op_sel_hi:[1,0]
    v_pk_fma_f32 v[116:117], v[118:119], v[112:113], v[58:59] op_sel_hi:[0,1,1] neg_lo:[0,0,1]
    v_cvt_pk_bf16_f32 v62, v116, -v117
    ds_write_b32 v9, v62 offset:28288
    v_cvt_pk_bf16_f32 v63, v120, v121
    ds_write_b32 v9, v63 offset:15232
    v_pk_mul_f32 v[60:61], v[120:121], v[110:111] op_sel:[1,1] op_sel_hi:[1,0]
    v_pk_fma_f32 v[76:77], v[120:121], v[110:111], v[60:61] op_sel_hi:[0,1,1] neg_lo:[0,0,1]
    v_cvt_pk_bf16_f32 v64, v76, v77
    ds_write_b32 v9, v64 offset:15776
    v_pk_mul_f32 v[60:61], v[120:121], v[66:67] op_sel:[1,1] op_sel_hi:[1,0]
    v_pk_fma_f32 v[122:123], v[120:121], v[66:67], v[60:61] op_sel_hi:[0,1,1] neg_lo:[0,0,1]
    s_waitcnt vmcnt(0)
    s_barrier
    ds_write_b128 v127, v[88:91]
    s_cmp_lg_u32 s3, 3
    s_cbranch_scc1 L_nosig1b
    s_lshl_b32 s54, s2, 7
    s_add_u32 s54, s54, 24150016
    v_lshl_add_u32 v96, v2, 2, s54
    s_mov_b64 exec, 0xffffffff
    global_store_dword v96, v15, s[4:5] sc1
    s_mov_b64 exec, -1
L_nosig1b:
    s_cmp_eq_u32 s3, 7
    s_cbranch_scc1 L_adaLN_cond__ssm_conv_s4__glu_gated_glu__prompt_kernel_now2
    global_load_dwordx4 v[80:83], v124, s[36:37] nt
    global_load_dwordx4 v[84:87], v124, s[38:39] nt
L_adaLN_cond__ssm_conv_s4__glu_gated_glu__prompt_kernel_now2:
    v_pk_mul_f32 v[58:59], v[116:117], v[112:113] op_sel:[1,1] op_sel_hi:[1,0]
    v_pk_fma_f32 v[118:119], v[116:117], v[112:113], v[58:59] op_sel_hi:[0,1,1] neg_lo:[0,0,1]
    v_cvt_pk_bf16_f32 v65, v118, -v119
    ds_write_b32 v9, v65 offset:28832
    v_cvt_pk_bf16_f32 v62, v122, v123
    ds_write_b32 v9, v62 offset:16320
    v_pk_mul_f32 v[60:61], v[122:123], v[110:111] op_sel:[1,1] op_sel_hi:[1,0]
    v_pk_fma_f32 v[76:77], v[122:123], v[110:111], v[60:61] op_sel_hi:[0,1,1] neg_lo:[0,0,1]
    v_cvt_pk_bf16_f32 v63, v76, v77
    ds_write_b32 v9, v63 offset:16864
    v_pk_mul_f32 v[60:61], v[122:123], v[66:67] op_sel:[1,1] op_sel_hi:[1,0]
    v_pk_fma_f32 v[120:121], v[122:123], v[66:67], v[60:61] op_sel_hi:[0,1,1] neg_lo:[0,0,1]
    v_pk_mul_f32 v[58:59], v[118:119], v[112:113] op_sel:[1,1] op_sel_hi:[1,0]
    v_pk_fma_f32 v[116:117], v[118:119], v[112:113], v[58:59] op_sel_hi:[0,1,1] neg_lo:[0,0,1]
    v_cvt_pk_bf16_f32 v64, v116, -v117
    ds_write_b32 v9, v64 offset:29376
    v_cvt_pk_bf16_f32 v65, v120, v121
    ds_write_b32 v9, v65 offset:17408
    v_pk_mul_f32 v[60:61], v[120:121], v[66:67] op_sel:[1,1] op_sel_hi:[1,0]
    v_pk_fma_f32 v[122:123], v[120:121], v[66:67], v[60:61] op_sel_hi:[0,1,1] neg_lo:[0,0,1]
    v_pk_mul_f32 v[58:59], v[116:117], v[112:113] op_sel:[1,1] op_sel_hi:[1,0]
    v_pk_fma_f32 v[118:119], v[116:117], v[112:113], v[58:59] op_sel_hi:[0,1,1] neg_lo:[0,0,1]
    v_cvt_pk_bf16_f32 v62, v118, -v119
    ds_write_b32 v9, v62 offset:29920
    v_cvt_pk_bf16_f32 v63, v122, v123
    ds_write_b32 v9, v63 offset:17952
    v_pk_mul_f32 v[60:61], v[122:123], v[66:67] op_sel:[1,1] op_sel_hi:[1,0]
    v_pk_fma_f32 v[120:121], v[122:123], v[66:67], v[60:61] op_sel_hi:[0,1,1] neg_lo:[0,0,1]
    v_pk_mul_f32 v[58:59], v[118:119], v[112:113] op_sel:[1,1] op_sel_hi:[1,0]
    v_pk_fma_f32 v[116:117], v[118:119], v[112:113], v[58:59] op_sel_hi:[0,1,1] neg_lo:[0,0,1]
    v_cvt_pk_bf16_f32 v64, v116, -v117
    ds_write_b32 v9, v64 offset:30464
    v_cvt_pk_bf16_f32 v65, v120, v121
    ds_write_b32 v9, v65 offset:18496
    v_pk_mul_f32 v[60:61], v[120:121], v[66:67] op_sel:[1,1] op_sel_hi:[1,0]
    v_pk_fma_f32 v[122:123], v[120:121], v[66:67], v[60:61] op_sel_hi:[0,1,1] neg_lo:[0,0,1]
    v_pk_mul_f32 v[58:59], v[116:117], v[112:113] op_sel:[1,1] op_sel_hi:[1,0]
    v_pk_fma_f32 v[118:119], v[116:117], v[112:113], v[58:59] op_sel_hi:[0,1,1] neg_lo:[0,0,1]
    v_cvt_pk_bf16_f32 v62, v118, -v119
    ds_write_b32 v9, v62 offset:31008
    v_cvt_pk_bf16_f32 v63, v122, v123
    ds_write_b32 v9, v63 offset:19040
    v_pk_mul_f32 v[60:61], v[122:123], v[66:67] op_sel:[1,1] op_sel_hi:[1,0]
    v_pk_fma_f32 v[120:121], v[122:123], v[66:67], v[60:61] op_sel_hi:[0,1,1] neg_lo:[0,0,1]
    v_pk_mul_f32 v[58:59], v[118:119], v[112:113] op_sel:[1,1] op_sel_hi:[1,0]
    v_pk_fma_f32 v[116:117], v[118:119], v[112:113], v[58:59] op_sel_hi:[0,1,1] neg_lo:[0,0,1]
    v_cvt_pk_bf16_f32 v64, v116, -v117
    ds_write_b32 v9, v64 offset:31552
    v_cvt_pk_bf16_f32 v65, v120, v121
    ds_write_b32 v9, v65 offset:19584
    v_pk_mul_f32 v[60:61], v[120:121], v[66:67] op_sel:[1,1] op_sel_hi:[1,0]
    v_pk_fma_f32 v[122:123], v[120:121], v[66:67], v[60:61] op_sel_hi:[0,1,1] neg_lo:[0,0,1]
    v_pk_mul_f32 v[58:59], v[116:117], v[112:113] op_sel:[1,1] op_sel_hi:[1,0]
    v_pk_fma_f32 v[118:119], v[116:117], v[112:113], v[58:59] op_sel_hi:[0,1,1] neg_lo:[0,0,1]
    v_cvt_pk_bf16_f32 v62, v118, -v119
    ds_write_b32 v9, v62 offset:32096
    v_cvt_pk_bf16_f32 v63, v122, v123
    ds_write_b32 v9, v63 offset:20128
    v_pk_mul_f32 v[60:61], v[122:123], v[66:67] op_sel:[1,1] op_sel_hi:[1,0]
    v_pk_fma_f32 v[120:121], v[122:123], v[66:67], v[60:61] op_sel_hi:[0,1,1] neg_lo:[0,0,1]
    v_pk_mul_f32 v[58:59], v[118:119], v[112:113] op_sel:[1,1] op_sel_hi:[1,0]
    v_pk_fma_f32 v[116:117], v[118:119], v[112:113], v[58:59] op_sel_hi:[0,1,1] neg_lo:[0,0,1]
    v_cvt_pk_bf16_f32 v64, v116, -v117
    ds_write_b32 v9, v64 offset:32640
    v_cvt_pk_bf16_f32 v65, v120, v121
    ds_write_b32 v9, v65 offset:20672
    v_pk_mul_f32 v[60:61], v[120:121], v[66:67] op_sel:[1,1] op_sel_hi:[1,0]
    v_pk_fma_f32 v[122:123], v[120:121], v[66:67], v[60:61] op_sel_hi:[0,1,1] neg_lo:[0,0,1]
    v_pk_mul_f32 v[58:59], v[116:117], v[112:113] op_sel:[1,1] op_sel_hi:[1,0]
    v_pk_fma_f32 v[118:119], v[116:117], v[112:113], v[58:59] op_sel_hi:[0,1,1] neg_lo:[0,0,1]
    v_cvt_pk_bf16_f32 v62, v118, -v119
    ds_write_b32 v9, v62 offset:33184
    v_cvt_pk_bf16_f32 v63, v122, v123
    ds_write_b32 v9, v63 offset:21216
    v_pk_mul_f32 v[60:61], v[122:123], v[66:67] op_sel:[1,1] op_sel_hi:[1,0]
    v_pk_fma_f32 v[120:121], v[122:123], v[66:67], v[60:61] op_sel_hi:[0,1,1] neg_lo:[0,0,1]
    v_pk_mul_f32 v[58:59], v[118:119], v[112:113] op_sel:[1,1] op_sel_hi:[1,0]
    v_pk_fma_f32 v[116:117], v[118:119], v[112:113], v[58:59] op_sel_hi:[0,1,1] neg_lo:[0,0,1]
    v_cvt_pk_bf16_f32 v64, v116, -v117
    ds_write_b32 v9, v64 offset:33728
    v_cvt_pk_bf16_f32 v65, v120, v121
    ds_write_b32 v9, v65 offset:21760
    v_pk_mul_f32 v[58:59], v[116:117], v[112:113] op_sel:[1,1] op_sel_hi:[1,0]
    v_pk_fma_f32 v[118:119], v[116:117], v[112:113], v[58:59] op_sel_hi:[0,1,1] neg_lo:[0,0,1]
    v_cvt_pk_bf16_f32 v62, v118, -v119
    ds_write_b32 v9, v62 offset:34272
L_uv_done:
    s_waitcnt lgkmcnt(0)
    s_barrier
    s_and_b32 s55, s3, 3
    s_cmp_eq_u32 s55, 3
    s_cbranch_scc1 L_b3
    s_mul_i32 s54, s55, 8704
    v_add_u32 v56, s54, v11
    ds_read_b128 v[192:195], v56 offset:0
    ds_read_b128 v[196:199], v11 offset:26112
    ds_read_b128 v[200:203], v56 offset:64
    ds_read_b128 v[204:207], v11 offset:26176
    ds_read_b128 v[208:211], v56 offset:128
    ds_read_b128 v[212:215], v11 offset:26240
    ds_read_b128 v[216:219], v56 offset:192
    ds_read_b128 v[220:223], v11 offset:26304
    ds_read_b128 v[224:227], v56 offset:256
    ds_read_b128 v[228:231], v11 offset:26368
    ds_read_b128 v[232:235], v56 offset:320
    ds_read_b128 v[236:239], v11 offset:26432
    ds_read_b128 v[240:243], v56 offset:384
    ds_read_b128 v[244:247], v11 offset:26496
    ds_read_b128 v[248:251], v56 offset:448
    ds_read_b128 v[252:255], v11 offset:26560
    s_waitcnt lgkmcnt(14)
    v_mfma_f32_16x16x32_bf16 v[60:63], v[192:195], v[196:199], 0
    s_waitcnt lgkmcnt(12)
    v_mfma_f32_16x16x32_bf16 v[60:63], v[200:203], v[204:207], v[60:63]
    s_waitcnt lgkmcnt(10)
    v_mfma_f32_16x16x32_bf16 v[60:63], v[208:211], v[212:215], v[60:63]
    s_waitcnt lgkmcnt(8)
    v_mfma_f32_16x16x32_bf16 v[60:63], v[216:219], v[220:223], v[60:63]
    s_waitcnt lgkmcnt(6)
    v_mfma_f32_16x16x32_bf16 v[60:63], v[224:227], v[228:231], v[60:63]
    s_waitcnt lgkmcnt(4)
    v_mfma_f32_16x16x32_bf16 v[60:63], v[232:235], v[236:239], v[60:63]
    s_waitcnt lgkmcnt(2)
    v_mfma_f32_16x16x32_bf16 v[60:63], v[240:243], v[244:247], v[60:63]
    s_waitcnt lgkmcnt(0)
    v_mfma_f32_16x16x32_bf16 v[60:63], v[248:251], v[252:255], v[60:63]
    s_nop 7
    v_cvt_pk_bf16_f32 v64, v60, v61
    v_cvt_pk_bf16_f32 v65, v62, v63
    ds_write_b16 v52, v64
    ds_write_b16_d16_hi v53, v64
    ds_write_b16 v54, v65
    ds_write_b16_d16_hi v55, v65
L_b3:
    v_lshlrev_b32 v108, 9, v2
    v_add_u32 v108, 24150016, v108
    s_cmp_lg_u32 s3, 7
    s_cbranch_scc1 L_nofp
L_nofp:
    v_and_b32 v97, 3, v2
    v_bfe_u32 v98, v2, 3, 1
    s_and_b32 s55, s3, 1
    s_xor_b32 s56, s55, 1
    v_bfe_u32 v99, v2, 2, 1
    v_lshl_add_u32 v99, v4, 1, v99
    v_and_b32 v100, s56, v98
    v_lshl_add_u32 v100, v100, 3, v99
    v_lshl_add_u32 v98, v98, 3, v99
    s_lshl_b32 s55, s55, 12
    s_lshr_b32 s54, s3, 2
    s_lshl_b32 s54, s54, 6
    s_add_u32 s55, s55, s54
    s_bfe_u32 s54, s3, 0x10001
    s_lshl_b32 s54, s54, 3
    s_add_u32 s55, s55, s54
    s_add_u32 s55, s55, 144128
    v_lshl_add_u32 v97, v97, 4, s55
    v_lshl_add_u32 v151, v98, 7, v97
    v_lshl_add_u32 v152, v100, 7, v97
    s_and_b32 s54, s2, 7
    s_lshl_b32 s54, s54, 2
    s_lshr_b32 s55, s3, 1
    s_add_u32 s54, s54, s55
    s_lshl_b32 s54, s54, 5
    s_lshr_b32 s55, s2, 3
    s_add_u32 s54, s54, s55
    s_mul_i32 s54, s54, 1792
    s_add_u32 s54, s54, 12582912
    v_mul_u32_u24 v97, 12, v2
    v_add_u32 v97, 1024, v97
    s_bitcmp1_b32 s3, 0
    s_cselect_b64 vcc, -1, 0
    v_cndmask_b32 v97, v12, v97, vcc
    v_add_u32 v148, s54, v97
    ds_read_b64_tr_b16 v[136:137], v151
    ds_read_b64_tr_b16 v[138:139], v152 offset:2048
    s_waitcnt lgkmcnt(0)
    s_cmp_eq_u32 s3, 7
    s_cbranch_scc1 L_nowd7
    s_bitcmp1_b32 s3, 0
    s_cbranch_scc1 L_adaLN_cond__ssm_conv_s4__glu_gated_glu__prompt_kernel_wd3a
    global_store_dwordx4 v148, v[136:139], s[4:5] sc1
    s_branch L_adaLN_cond__ssm_conv_s4__glu_gated_glu__prompt_kernel_wd3b
L_adaLN_cond__ssm_conv_s4__glu_gated_glu__prompt_kernel_wd3a:
    global_store_dwordx3 v148, v[136:138], s[4:5] sc1
L_adaLN_cond__ssm_conv_s4__glu_gated_glu__prompt_kernel_wd3b:
L_nowd7:
    s_barrier
    s_cmp_lg_u32 s3, 7
    s_cbranch_scc1 L_nofp2
    global_load_dword v104, v108, s[4:5] sc1
    global_load_dword v105, v108, s[4:5] offset:128 sc1
    global_load_dword v106, v108, s[4:5] offset:256 sc1
    global_load_dword v107, v108, s[4:5] offset:384 sc1
L_nofp2:
    v_mov_b32 v62, 0
    v_mov_b32 v63, 0
    v_mov_b32 v64, 0
    v_mov_b32 v65, 0
    v_mov_b32 v66, 0
    v_mov_b32 v67, 0
    ds_read_u16 v56, v40
    ds_read_u16_d16_hi v62, v41
    ds_read_u16 v57, v42
    ds_read_u16_d16_hi v63, v43
    ds_read_u16 v58, v44
    ds_read_u16_d16_hi v64, v45
    ds_read_u16 v59, v46
    ds_read_u16_d16_hi v65, v47
    ds_read_u16 v60, v48
    ds_read_u16_d16_hi v66, v49
    ds_read_u16 v61, v50
    ds_read_u16_d16_hi v67, v51
    s_and_b32 s54, s3, 3
    s_mul_i32 s54, s54, 4160
    s_add_u32 s54, s54, s52
    s_add_u32 s54, s54, 4096
    v_and_b32 v96, 1, v2
    v_lshl_add_u32 v96, v96, 4, s54
    v_add_u32 v97, s53, v12
    v_cmp_gt_u32 vcc, 32, v2
    v_mov_b32 v100, 0
    v_mov_b32 v101, 0
    v_mov_b32 v102, 0
    v_mov_b32 v103, 0
    v_cndmask_b32 v96, v96, v97, vcc
    ds_write_b128 v96, v[100:103]
    v_lshl_add_u32 v96, v13, 4, s52
    v_cmp_eq_u32 vcc, 255, v13
    s_waitcnt lgkmcnt(1)
    v_or_b32 v56, v56, v62
    v_or_b32 v57, v57, v63
    v_or_b32 v58, v58, v64
    v_or_b32 v59, v59, v65
    v_or_b32 v60, v60, v66
    v_or_b32 v61, v61, v67
    v_cndmask_b32 v60, v60, 0, vcc
    v_cndmask_b32 v61, v61, 0, vcc
    ds_write_b128 v96, v[56:59]
    v_alignbit_b32 v68, v57, v56, 16
    v_alignbit_b32 v69, v58, v57, 16
    v_alignbit_b32 v70, v59, v58, 16
    v_alignbit_b32 v71, v60, v59, 16
    ds_write_b128 v96, v[68:71] offset:4160
    v_mov_b32 v72, v57
    v_mov_b32 v73, v58
    v_mov_b32 v74, v59
    v_mov_b32 v75, v60
    ds_write_b128 v96, v[72:75] offset:8320
    v_alignbit_b32 v76, v58, v57, 16
    v_alignbit_b32 v77, v59, v58, 16
    v_alignbit_b32 v78, v60, v59, 16
    v_alignbit_b32 v79, v61, v60, 16
    ds_write_b128 v96, v[76:79] offset:12480
    s_cmp_lg_u32 s3, 7
    s_cbranch_scc1 L_b5
    s_mov_b32 s61, 0x40000
    s_branch L_s1_chk
L_s1_poll:
    global_load_dword v104, v108, s[4:5] sc1
    global_load_dword v105, v108, s[4:5] offset:128 sc1
    global_load_dword v106, v108, s[4:5] offset:256 sc1
    global_load_dword v107, v108, s[4:5] offset:384 sc1
L_s1_chk:
    s_waitcnt vmcnt(0)
    v_xor_b32 v104, v15, v104
    v_xor_b32 v105, v15, v105
    v_xor_b32 v106, v15, v106
    v_xor_b32 v107, v15, v107
    v_or3_b32 v104, v104, v105, v106
    v_or_b32 v104, v104, v107
    v_cmp_ne_u32 vcc, 0, v104
    s_cbranch_vccz L_s1_ok
    s_nop 0
    s_mov_b64 exec, vcc
    s_sleep 1
    s_sub_u32 s61, s61, 1
    s_cbranch_scc0 L_s1_poll
L_s1_ok:
    s_mov_b64 exec, -1
    s_bitcmp1_b32 s3, 0
    s_cbranch_scc1 L_adaLN_cond__ssm_conv_s4__glu_gated_glu__prompt_kernel_wd4a
    global_store_dwordx4 v148, v[136:139], s[4:5] sc1
    s_branch L_adaLN_cond__ssm_conv_s4__glu_gated_glu__prompt_kernel_wd4b
L_adaLN_cond__ssm_conv_s4__glu_gated_glu__prompt_kernel_wd4a:
    global_store_dwordx3 v148, v[136:138], s[4:5] sc1
L_adaLN_cond__ssm_conv_s4__glu_gated_glu__prompt_kernel_wd4b:
L_b5:
    s_waitcnt lgkmcnt(0)
    s_barrier
    global_load_dword v36, v20, s[4:5] sc1
    global_load_dwordx4 v[24:27], v6, s[4:5] sc1
    v_add_u32 v6, 2359296, v6
    s_cmp_lg_u32 s3, 7
    s_cbranch_scc1 L_nomodl
    global_load_dword v32, v21, s[4:5] sc1
    v_add_u32 v21, 12288, v21
    global_load_dword v33, v21, s[4:5] sc1
    v_add_u32 v21, 12288, v21
    global_load_dword v34, v21, s[4:5] sc1
    v_add_u32 v21, 12288, v21
    global_load_dword v35, v21, s[4:5] sc1
    v_add_u32 v21, 12288, v21
L_nomodl:
    s_lshl_b32 s54, s3, 2
    s_lshr_b32 s56, 0x23450167, s54
    s_and_b32 s56, s56, 15
    v_add_u32 v8, 1, v4
    v_and_b32 v8, 3, v8
    v_lshlrev_b32 v8, 3, v8
    v_lshl_add_u32 v8, v3, 5, v8
    s_lshl_b32 s56, s56, 9
    v_add_u32 v8, s56, v8
    s_and_b32 s57, s3, 3
    s_lshl_b32 s58, s57, 7
    v_add_u32 v7, 119040, v8
    v_add_u32 v5, 4, v3
    v_and_b32 v5, 15, v5
    v_sub_u32 v5, 2031, v5
    v_lshl_add_u32 v5, v4, 3, v5
    v_and_b32 v0, 3, v5
    v_lshrrev_b32 v5, 2, v5
    v_lshlrev_b32 v5, 3, v5
    v_mul_u32_u24 v0, 4160, v0
    v_add_u32 v5, v5, v0
    s_sub_u32 s54, 81600, s58
    v_add_u32 v5, s54, v5
    v_lshlrev_b32 v0, 4, v4
    v_lshl_add_u32 v0, v3, 5, v0
    s_sub_u32 s54, 118944, s58
    v_add_u32 v0, s54, v0
    s_lshl_b32 s54, s49, 14
    s_lshl_b32 s55, s57, 10
    s_add_u32 s55, s55, s54
    v_add_u32 v14, s55, v12
    s_lshl_b32 s55, s57, 12
    s_add_u32 s55, s55, s54
    v_add_u32 v38, s55, v12
    s_min_u32 s54, s3, 6
    s_lshl_b32 s54, s54, 1
    v_bfe_u32 v96, v2, 2, 2
    v_and_b32 v97, 1, v4
    v_lshl_or_b32 v97, v97, 2, v96
    v_xor_b32 v97, s54, v97
    v_lshlrev_b32 v97, 5, v97
    v_lshl_add_u32 v96, v4, 3, v96
    v_lshl_add_u32 v96, v96, 9, v97
    v_and_b32 v97, 3, v2
    v_lshl_add_u32 v96, v97, 3, v96
    v_add_u32 v149, 127744, v96
    v_xor_b32 v150, 32, v149
    v_lshlrev_b32 v142, 5, v4
    v_add_u32 v142, 151296, v142
    v_lshlrev_b32 v141, 4, v4
    v_add_u32 v143, 151424, v141
    v_mov_b32 v144, 0x3f803f80
    v_mov_b32 v145, v144
    v_mov_b32 v146, v144
    v_mov_b32 v147, v144
    s_min_u32 s54, s3, 6
    s_mul_i32 s55, s2, 14336
    s_lshl_b32 s56, s54, 11
    s_add_u32 s55, s55, s56
    s_add_u32 s55, s55, 8388608
    v_add_u32 v140, s55, v12
    s_and_b32 s55, s2, 15
    s_mul_i32 s55, s55, 28672
    s_lshr_b32 s56, s2, 4
    s_mul_i32 s56, s56, 1792
    s_add_u32 s55, s55, s56
    s_lshl_b32 s56, s54, 8
    s_add_u32 s55, s55, s56
    s_add_u32 s55, s55, 23199744
    v_add_u32 v141, s55, v141
    v_lshl_add_u32 v141, v3, 6, v141
    v_cmp_eq_u32 s[28:29], 1, v3
    v_cmp_eq_u32 s[30:31], 2, v3
    v_cmp_eq_u32 s[32:33], 3, v3
    v_add_u32 v39, 65536, v8
    v_and_b32 v96, 1, v2
    v_cmp_eq_u32 s[22:23], 0, v96
    s_cmp_eq_u32 s3, 7
    s_cbranch_scc1 L_noraw
    s_waitcnt vmcnt(2)
    ds_write2_b32 v126, v80, v84 offset0:0 offset1:1
    ds_write2_b32 v126, v81, v85 offset0:2 offset1:3
    ds_write2_b32 v126, v82, v86 offset0:4 offset1:5
    ds_write2_b32 v126, v83, v87 offset0:6 offset1:7
L_noraw:
    v_mov_b32 v96, 151488
    v_mov_b32 v97, 0
    ds_write2_b32 v96, v97, v97 offset1:1
    s_cmp_lg_u32 s3, 7
    s_cbranch_scc1 L_nomods
    v_lshlrev_b32 v23, 1, v22
    v_add_u32 v23, 151424, v23
    v_lshlrev_b32 v22, 2, v22
    v_add_u32 v22, 151296, v22
    s_waitcnt vmcnt(0)
    v_add_f32 v32, v32, v33
    v_add_f32 v34, v34, v35
    v_add_f32 v32, v32, v34
    v_cvt_pk_bf16_f32 v33, v32, v32
    v_and_b32 v32, v1, v33
    v_add_f32 v32, 1.0, v32
    v_cvt_pk_bf16_f32 v32, v32, v32
    v_and_b32 v32, v1, v32
    s_mov_b64 exec, 0xffffffff
    ds_write_b16 v23, v33
    s_not_b64 exec, exec
    ds_write_b32 v22, v32
    s_mov_b64 exec, -1
L_nomods:
    s_waitcnt vmcnt(1)
    v_add_f32_dpp v16, v36, v36 quad_perm:[1,0,3,2] row_mask:0xf bank_mask:0xf
    s_nop 1
    v_add_f32_dpp v16, v16, v16 quad_perm:[2,3,0,1] row_mask:0xf bank_mask:0xf
    v_cvt_pk_bf16_f32 v16, v16, v16
    v_and_b32 v16, v1, v16
    v_add_f32 v17, 1.0, v16
    v_cvt_pk_bf16_f32 v17, v17, v17
    v_and_b32 v17, v1, v17
    v_readlane_b32 s16, v16, 0
    v_readlane_b32 s17, v17, 4
    v_readlane_b32 s18, v16, 8
    v_readlane_b32 s19, v16, 16
    v_readlane_b32 s20, v17, 20
    v_readlane_b32 s21, v16, 24
    v_mov_b32 v16, s16
    v_mov_b32 v17, s17
    v_mov_b32 v18, s19
    v_mov_b32 v19, s20
    v_cndmask_b32 v52, v18, v16, s[22:23]
    v_cndmask_b32 v53, v19, v17, s[22:23]
    s_lshl_b32 s58, s59, 16
    s_and_b32 s59, s59, 0xffff0000
    s_and_b32 s50, s2, 7
    s_lshl_b32 s50, s50, 2
    s_bfe_u32 s51, s2, 0x20003
    s_add_u32 s50, s50, s51
    s_lshr_b32 s51, s2, 5
    s_lshr_b32 s56, s3, 2
    s_lshl_b32 s57, s51, 1
    s_add_u32 s44, s57, s56
    s_xor_b32 s56, s56, 1
    s_add_u32 s45, s57, s56
    s_mul_i32 s44, s44, 114688
    s_mul_i32 s45, s45, 114688
    s_mul_i32 s56, s3, 7168
    s_add_u32 s40, s44, s56
    s_add_u32 s41, s40, 57344
    s_add_u32 s42, s45, s56
    s_add_u32 s43, s42, 57344
    s_add_u32 s44, s4, 12582912
    s_addc_u32 s45, s5, 0
    s_mov_b32 s46, 1835008
    s_mov_b32 s47, 0x20000
    v_mul_u32_u24 v126, 12, v2
    v_and_b32 v124, 31, v2
    v_lshl_add_u32 v124, v124, 3, s51
    v_lshlrev_b32 v124, 7, v124
    v_add_u32 v124, 24281088, v124
    s_lshr_b32 s54, s48, 1
    s_mul_i32 s54, s54, 4224
    s_add_u32 s54, s54, 1048576
    v_add_u32 v8, s54, v8
    s_cmp_ge_u32 s3, 4
    s_cbranch_scc1 L_pa1
    ds_read_b64 v[56:57], v5 offset:3648
    ds_read_b64 v[58:59], v5 offset:3656
    ds_read_b64 v[60:61], v5 offset:3136
    ds_read_b64 v[62:63], v5 offset:3144
    ds_read_b64 v[64:65], v5 offset:2624
    ds_read_b64 v[66:67], v5 offset:2632
    ds_read_b64 v[68:69], v5 offset:2112
    ds_read_b64 v[70:71], v5 offset:2120
    ds_read_b64 v[72:73], v5 offset:1600
    ds_read_b64 v[74:75], v5 offset:1608
    ds_read_b64 v[76:77], v5 offset:1088
    ds_read_b64 v[78:79], v5 offset:1096
    ds_read_b64 v[80:81], v5 offset:576
    ds_read_b64 v[82:83], v5 offset:584
    ds_read_b64 v[84:85], v5 offset:64
    ds_read_b64 v[86:87], v5 offset:72
    s_branch L_pa2
L_pa1:
    ds_read_b64 v[56:57], v5 offset:3648
    ds_read_b64 v[58:59], v5 offset:3656
    ds_read_b64 v[60:61], v5 offset:3136
    ds_read_b64 v[62:63], v5 offset:3144
    ds_read_b64 v[64:65], v5 offset:2624
    ds_read_b64 v[66:67], v5 offset:2632
    ds_read_b64 v[68:69], v5 offset:2112
    ds_read_b64 v[70:71], v5 offset:2120
    ds_read_b64 v[72:73], v5 offset:1600
    ds_read_b64 v[74:75], v5 offset:1608
    ds_read_b64 v[76:77], v5 offset:1088
    ds_read_b64 v[78:79], v5 offset:1096
L_pa2:
    s_waitcnt vmcnt(0)
    global_load_dwordx4 v[120:123], v6, s[4:5] sc1
    v_lshlrev_b32 v104, 16, v24
    v_and_b32 v105, v1, v24
    v_lshlrev_b32 v106, 16, v25
    v_and_b32 v107, v1, v25
    v_lshlrev_b32 v108, 16, v26
    v_and_b32 v109, v1, v26
    v_lshlrev_b32 v110, 16, v27
    v_and_b32 v111, v1, v27
    v_fma_f32 v104, v104, v53, v52
    v_fma_f32 v105, v105, v53, v52
    v_fma_f32 v106, v106, v53, v52
    v_fma_f32 v107, v107, v53, v52
    v_fma_f32 v108, v108, v53, v52
    v_fma_f32 v109, v109, v53, v52
    v_fma_f32 v110, v110, v53, v52
    v_fma_f32 v111, v111, v53, v52
    v_cvt_pk_bf16_f32 v24, v104, v105
    v_cvt_pk_bf16_f32 v25, v106, v107
    v_cvt_pk_bf16_f32 v26, v108, v109
    v_cvt_pk_bf16_f32 v27, v110, v111
    ds_write_b128 v10, v[24:27]
    v_mov_b32 v52, s18
    v_mov_b32 v53, s58
    v_mov_b32 v54, s21
    v_mov_b32 v55, s59
    s_waitcnt lgkmcnt(0)
    s_barrier
    s_cmp_lg_u32 s3, 3
    s_cbranch_scc1 L_nowf
    s_lshl_b32 s54, s2, 7
    s_add_u32 s54, s54, 24281088
    v_lshl_add_u32 v24, v2, 2, s54
    s_mov_b64 exec, 0xffffffff
    global_store_dword v24, v15, s[4:5] sc1
    s_mov_b64 exec, -1
L_nowf:
    s_cmp_lt_u32 s3, 4
    s_cbranch_scc1 L_noprep1
    ds_read_b128 v[108:111], v0 offset:2624
    ds_read_b128 v[104:107], v0 offset:2112
    ds_read_b128 v[100:103], v0 offset:1600
    ds_read_b128 v[96:99], v0 offset:1088
    ds_read_b128 v[92:95], v0 offset:576
    ds_read_b128 v[88:91], v0 offset:64
    ds_read_b64_tr_b16 v[128:129], v149
    ds_read_b64_tr_b16 v[130:131], v149 offset:2048
    ds_read_b64_tr_b16 v[132:133], v150
    ds_read_b64_tr_b16 v[134:135], v150 offset:2048
    ds_read_b128 v[192:195], v142
    ds_read_b128 v[196:199], v142 offset:16
    ds_read_b128 v[160:163], v143
    s_waitcnt lgkmcnt(0)
    v_mfma_f32_16x16x32_bf16 v[180:183], v[128:131], v[160:163], 0
    v_mfma_f32_16x16x32_bf16 v[188:191], v[132:135], v[160:163], 0
    v_lshlrev_b32 v164, 16, v128
    v_and_b32 v165, v1, v128
    v_mul_f32 v164, v164, v192
    v_mul_f32 v165, v165, v193
    v_cvt_pk_bf16_f32 v168, v164, v165
    v_lshlrev_b32 v166, 16, v129
    v_and_b32 v167, v1, v129
    v_mul_f32 v166, v166, v194
    v_mul_f32 v167, v167, v195
    v_cvt_pk_bf16_f32 v169, v166, v167
    v_lshlrev_b32 v164, 16, v130
    v_and_b32 v165, v1, v130
    v_mul_f32 v164, v164, v196
    v_mul_f32 v165, v165, v197
    v_cvt_pk_bf16_f32 v170, v164, v165
    v_lshlrev_b32 v166, 16, v131
    v_and_b32 v167, v1, v131
    v_mul_f32 v166, v166, v198
    v_mul_f32 v167, v167, v199
    v_cvt_pk_bf16_f32 v171, v166, v167
    v_lshlrev_b32 v164, 16, v132
    v_and_b32 v165, v1, v132
    v_mul_f32 v164, v164, v192
    v_mul_f32 v165, v165, v193
    v_cvt_pk_bf16_f32 v172, v164, v165
    v_lshlrev_b32 v166, 16, v133
    v_and_b32 v167, v1, v133
    v_mul_f32 v166, v166, v194
    v_mul_f32 v167, v167, v195
    v_cvt_pk_bf16_f32 v173, v166, v167
    v_lshlrev_b32 v164, 16, v134
    v_and_b32 v165, v1, v134
    v_mul_f32 v164, v164, v196
    v_mul_f32 v165, v165, v197
    v_cvt_pk_bf16_f32 v174, v164, v165
    v_lshlrev_b32 v166, 16, v135
    v_and_b32 v167, v1, v135
    v_mul_f32 v166, v166, v198
    v_mul_f32 v167, v167, v199
    v_cvt_pk_bf16_f32 v175, v166, v167
    global_store_dwordx4 v140, v[168:171], s[4:5] sc1
    global_store_dwordx4 v140, v[172:175], s[4:5] offset:1024 sc1
    v_mfma_f32_16x16x32_bf16 v[176:179], v[168:171], v[144:147], 0
    v_mfma_f32_16x16x32_bf16 v[184:187], v[172:175], v[144:147], 0
    s_nop 6
    v_cndmask_b32 v192, v176, v180, s[28:29]
    v_cndmask_b32 v192, v192, v184, s[30:31]
    v_cndmask_b32 v192, v192, v188, s[32:33]
    v_cndmask_b32 v193, v177, v181, s[28:29]
    v_cndmask_b32 v193, v193, v185, s[30:31]
    v_cndmask_b32 v193, v193, v189, s[32:33]
    v_cndmask_b32 v194, v178, v182, s[28:29]
    v_cndmask_b32 v194, v194, v186, s[30:31]
    v_cndmask_b32 v194, v194, v190, s[32:33]
    v_cndmask_b32 v195, v179, v183, s[28:29]
    v_cndmask_b32 v195, v195, v187, s[30:31]
    v_cndmask_b32 v195, v195, v191, s[32:33]
    s_mov_b32 exec_lo, 0x000f000f
    s_mov_b32 exec_hi, 0x000f000f
    global_store_dwordx4 v141, v[192:195], s[4:5] sc1
    s_mov_b64 exec, -1
L_noprep1:
    s_cmp_ge_u32 s3, 4
    s_cbranch_scc1 L_set1_0
    ds_read_b128 v[116:119], v0 offset:3648
    ds_read_b128 v[112:115], v0 offset:3136
    ds_read_b128 v[92:95], v0 offset:576
    ds_read_b128 v[88:91], v0 offset:64
    ds_read_b128 v[108:111], v0 offset:2624
    ds_read_b128 v[104:107], v0 offset:2112
    ds_read_b128 v[100:103], v0 offset:1600
    ds_read_b128 v[96:99], v0 offset:1088
    s_waitcnt lgkmcnt(4)
    v_mfma_f32_16x16x32_bf16 v[16:19], v[56:59], v[116:119], 0
    ds_read_b64 v[192:193], v5 offset:3584
    ds_read_b64 v[194:195], v5 offset:3592
    v_mfma_f32_16x16x32_bf16 v[20:23], v[56:59], v[112:115], 0
    ds_read_b128 v[252:255], v0 offset:3584
    ds_read_b128 v[248:251], v0 offset:3072
    v_mfma_f32_16x16x32_bf16 v[24:27], v[56:59], v[92:95], 0
    ds_read_b128 v[228:231], v0 offset:512
    ds_read_b128 v[224:227], v0 offset:0
    v_mfma_f32_16x16x32_bf16 v[28:31], v[56:59], v[88:91], 0
    ds_read_b64 v[196:197], v5 offset:3072
    ds_read_b64 v[198:199], v5 offset:3080
    s_waitcnt lgkmcnt(8)
    v_mfma_f32_16x16x32_bf16 v[16:19], v[60:63], v[112:115], v[16:19]
    ds_read_b128 v[244:247], v0 offset:2560
    ds_read_b64 v[200:201], v5 offset:2560
    v_mfma_f32_16x16x32_bf16 v[20:23], v[60:63], v[108:111], v[20:23]
    ds_read_b64 v[202:203], v5 offset:2568
    ds_read_b128 v[240:243], v0 offset:2048
    v_mfma_f32_16x16x32_bf16 v[24:27], v[60:63], v[88:91], v[24:27]
    ds_read_b64 v[204:205], v5 offset:2048
    ds_read_b64 v[206:207], v5 offset:2056
    v_mfma_f32_16x16x32_bf16 v[16:19], v[64:67], v[108:111], v[16:19]
    ds_read_b128 v[236:239], v0 offset:1536
    ds_read_b64 v[208:209], v5 offset:1536
    v_mfma_f32_16x16x32_bf16 v[20:23], v[64:67], v[104:107], v[20:23]
    ds_read_b64 v[210:211], v5 offset:1544
    ds_read_b128 v[232:235], v0 offset:1024
    v_mfma_f32_16x16x32_bf16 v[16:19], v[68:71], v[104:107], v[16:19]
    ds_read_b64 v[212:213], v5 offset:1024
    ds_read_b64 v[214:215], v5 offset:1032
    v_mfma_f32_16x16x32_bf16 v[20:23], v[68:71], v[100:103], v[20:23]
    ds_read_b64 v[216:217], v5 offset:512
    ds_read_b64 v[218:219], v5 offset:520
    v_mfma_f32_16x16x32_bf16 v[16:19], v[72:75], v[100:103], v[16:19]
    ds_read_b64 v[220:221], v5 offset:0
    ds_read_b64 v[222:223], v5 offset:8
    v_mfma_f32_16x16x32_bf16 v[20:23], v[72:75], v[96:99], v[20:23]
    v_mfma_f32_16x16x32_bf16 v[16:19], v[76:79], v[96:99], v[16:19]
    v_mfma_f32_16x16x32_bf16 v[20:23], v[76:79], v[92:95], v[20:23]
    v_mfma_f32_16x16x32_bf16 v[16:19], v[80:83], v[92:95], v[16:19]
    v_mfma_f32_16x16x32_bf16 v[20:23], v[80:83], v[88:91], v[20:23]
    v_mfma_f32_16x16x32_bf16 v[16:19], v[84:87], v[88:91], v[16:19]
    s_waitcnt lgkmcnt(0)
    v_mfma_f32_16x16x32_bf16 v[16:19], v[192:195], v[252:255], v[16:19]
    ds_read_b64 v[56:57], v5 offset:20288
    ds_read_b64 v[58:59], v5 offset:20296
    v_mfma_f32_16x16x32_bf16 v[20:23], v[192:195], v[248:251], v[20:23]
    ds_read_b128 v[116:119], v0 offset:8256
    ds_read_b128 v[112:115], v0 offset:7744
    v_mfma_f32_16x16x32_bf16 v[24:27], v[192:195], v[228:231], v[24:27]
    ds_read_b128 v[92:95], v0 offset:5184
    ds_read_b128 v[88:91], v0 offset:4672
    v_mfma_f32_16x16x32_bf16 v[28:31], v[192:195], v[224:227], v[28:31]
    ds_read_b64 v[60:61], v5 offset:19776
    ds_read_b64 v[62:63], v5 offset:19784
    v_mfma_f32_16x16x32_bf16 v[16:19], v[196:199], v[248:251], v[16:19]
    ds_read_b128 v[108:111], v0 offset:7232
    ds_read_b64 v[64:65], v5 offset:19264
    v_mfma_f32_16x16x32_bf16 v[20:23], v[196:199], v[244:247], v[20:23]
    ds_read_b64 v[66:67], v5 offset:19272
    ds_read_b128 v[104:107], v0 offset:6720
    v_mfma_f32_16x16x32_bf16 v[24:27], v[196:199], v[224:227], v[24:27]
    ds_read_b64 v[68:69], v5 offset:18752
    ds_read_b64 v[70:71], v5 offset:18760
    v_mfma_f32_16x16x32_bf16 v[16:19], v[200:203], v[244:247], v[16:19]
    ds_read_b128 v[100:103], v0 offset:6208
    ds_read_b64 v[72:73], v5 offset:18240
    v_mfma_f32_16x16x32_bf16 v[20:23], v[200:203], v[240:243], v[20:23]
    ds_read_b64 v[74:75], v5 offset:18248
    ds_read_b128 v[96:99], v0 offset:5696
    v_mfma_f32_16x16x32_bf16 v[16:19], v[204:207], v[240:243], v[16:19]
    ds_read_b64 v[76:77], v5 offset:17728
    ds_read_b64 v[78:79], v5 offset:17736
    v_mfma_f32_16x16x32_bf16 v[20:23], v[204:207], v[236:239], v[20:23]
    ds_read_b64 v[80:81], v5 offset:17216
    ds_read_b64 v[82:83], v5 offset:17224
    v_mfma_f32_16x16x32_bf16 v[16:19], v[208:211], v[236:239], v[16:19]
    ds_read_b64 v[84:85], v5 offset:16704
    ds_read_b64 v[86:87], v5 offset:16712
    v_mfma_f32_16x16x32_bf16 v[20:23], v[208:211], v[232:235], v[20:23]
    v_mfma_f32_16x16x32_bf16 v[16:19], v[212:215], v[232:235], v[16:19]
    v_mfma_f32_16x16x32_bf16 v[20:23], v[212:215], v[228:231], v[20:23]
    v_mfma_f32_16x16x32_bf16 v[16:19], v[216:219], v[228:231], v[16:19]
    v_mfma_f32_16x16x32_bf16 v[20:23], v[216:219], v[224:227], v[20:23]
    v_mfma_f32_16x16x32_bf16 v[16:19], v[220:223], v[224:227], v[16:19]
    s_branch L_conv_done0
L_set1_0:
    v_mfma_f32_16x16x32_bf16 v[16:19], v[56:59], v[108:111], 0
    ds_read_b64 v[192:193], v5 offset:3584
    ds_read_b64 v[194:195], v5 offset:3592
    v_mfma_f32_16x16x32_bf16 v[20:23], v[56:59], v[104:107], 0
    ds_read_b128 v[244:247], v0 offset:2560
    ds_read_b128 v[240:243], v0 offset:2048
    v_mfma_f32_16x16x32_bf16 v[24:27], v[56:59], v[100:103], 0
    ds_read_b128 v[236:239], v0 offset:1536
    ds_read_b128 v[232:235], v0 offset:1024
    v_mfma_f32_16x16x32_bf16 v[28:31], v[56:59], v[96:99], 0
    ds_read_b64 v[196:197], v5 offset:3072
    ds_read_b64 v[198:199], v5 offset:3080
    v_mfma_f32_16x16x32_bf16 v[16:19], v[60:63], v[104:107], v[16:19]
    ds_read_b128 v[228:231], v0 offset:512
    ds_read_b64 v[200:201], v5 offset:2560
    v_mfma_f32_16x16x32_bf16 v[20:23], v[60:63], v[100:103], v[20:23]
    ds_read_b64 v[202:203], v5 offset:2568
    ds_read_b128 v[224:227], v0 offset:0
    v_mfma_f32_16x16x32_bf16 v[24:27], v[60:63], v[96:99], v[24:27]
    ds_read_b64 v[204:205], v5 offset:2048
    ds_read_b64 v[206:207], v5 offset:2056
    v_mfma_f32_16x16x32_bf16 v[28:31], v[60:63], v[92:95], v[28:31]
    ds_read_b64 v[208:209], v5 offset:1536
    ds_read_b64 v[210:211], v5 offset:1544
    v_mfma_f32_16x16x32_bf16 v[16:19], v[64:67], v[100:103], v[16:19]
    ds_read_b64 v[212:213], v5 offset:1024
    ds_read_b64 v[214:215], v5 offset:1032
    v_mfma_f32_16x16x32_bf16 v[20:23], v[64:67], v[96:99], v[20:23]
    v_mfma_f32_16x16x32_bf16 v[24:27], v[64:67], v[92:95], v[24:27]
    v_mfma_f32_16x16x32_bf16 v[28:31], v[64:67], v[88:91], v[28:31]
    v_mfma_f32_16x16x32_bf16 v[16:19], v[68:71], v[96:99], v[16:19]
    v_mfma_f32_16x16x32_bf16 v[20:23], v[68:71], v[92:95], v[20:23]
    v_mfma_f32_16x16x32_bf16 v[24:27], v[68:71], v[88:91], v[24:27]
    v_mfma_f32_16x16x32_bf16 v[16:19], v[72:75], v[92:95], v[16:19]
    v_mfma_f32_16x16x32_bf16 v[20:23], v[72:75], v[88:91], v[20:23]
    v_mfma_f32_16x16x32_bf16 v[16:19], v[76:79], v[88:91], v[16:19]
    s_waitcnt lgkmcnt(0)
    v_mfma_f32_16x16x32_bf16 v[16:19], v[192:195], v[244:247], v[16:19]
    ds_read_b64 v[56:57], v5 offset:20288
    ds_read_b64 v[58:59], v5 offset:20296
    v_mfma_f32_16x16x32_bf16 v[20:23], v[192:195], v[240:243], v[20:23]
    ds_read_b128 v[108:111], v0 offset:7232
    ds_read_b128 v[104:107], v0 offset:6720
    v_mfma_f32_16x16x32_bf16 v[24:27], v[192:195], v[236:239], v[24:27]
    ds_read_b128 v[100:103], v0 offset:6208
    ds_read_b128 v[96:99], v0 offset:5696
    v_mfma_f32_16x16x32_bf16 v[28:31], v[192:195], v[232:235], v[28:31]
    ds_read_b64 v[60:61], v5 offset:19776
    ds_read_b64 v[62:63], v5 offset:19784
    v_mfma_f32_16x16x32_bf16 v[16:19], v[196:199], v[240:243], v[16:19]
    ds_read_b128 v[92:95], v0 offset:5184
    ds_read_b64 v[64:65], v5 offset:19264
    v_mfma_f32_16x16x32_bf16 v[20:23], v[196:199], v[236:239], v[20:23]
    ds_read_b64 v[66:67], v5 offset:19272
    ds_read_b128 v[88:91], v0 offset:4672
    v_mfma_f32_16x16x32_bf16 v[24:27], v[196:199], v[232:235], v[24:27]
    ds_read_b64 v[68:69], v5 offset:18752
    ds_read_b64 v[70:71], v5 offset:18760
    v_mfma_f32_16x16x32_bf16 v[28:31], v[196:199], v[228:231], v[28:31]
    ds_read_b64 v[72:73], v5 offset:18240
    ds_read_b64 v[74:75], v5 offset:18248
    v_mfma_f32_16x16x32_bf16 v[16:19], v[200:203], v[236:239], v[16:19]
    ds_read_b64 v[76:77], v5 offset:17728
    ds_read_b64 v[78:79], v5 offset:17736
    v_mfma_f32_16x16x32_bf16 v[20:23], v[200:203], v[232:235], v[20:23]
    v_mfma_f32_16x16x32_bf16 v[24:27], v[200:203], v[228:231], v[24:27]
    v_mfma_f32_16x16x32_bf16 v[28:31], v[200:203], v[224:227], v[28:31]
    v_mfma_f32_16x16x32_bf16 v[16:19], v[204:207], v[232:235], v[16:19]
    v_mfma_f32_16x16x32_bf16 v[20:23], v[204:207], v[228:231], v[20:23]
    v_mfma_f32_16x16x32_bf16 v[24:27], v[204:207], v[224:227], v[24:27]
    v_mfma_f32_16x16x32_bf16 v[16:19], v[208:211], v[228:231], v[16:19]
    v_mfma_f32_16x16x32_bf16 v[20:23], v[208:211], v[224:227], v[20:23]
    v_mfma_f32_16x16x32_bf16 v[16:19], v[212:215], v[224:227], v[16:19]
L_conv_done0:
    s_nop 5
    ds_read_b64 v[32:33], v7 offset:0
    s_nop 0
    ds_write_b128 v14, v[16:19] offset:0
    ds_write_b128 v14, v[20:23] offset:4096
    ds_write_b128 v14, v[24:27] offset:8192
    ds_write_b128 v14, v[28:31] offset:12288
    s_waitcnt vmcnt(0)
    ds_write_b128 v37, v[120:123]
    s_cmp_ge_u32 s3, 4
    s_cbranch_scc1 L_noprep2
    ds_read_b64_tr_b16 v[128:129], v149
    ds_read_b64_tr_b16 v[130:131], v149 offset:2048
    ds_read_b64_tr_b16 v[132:133], v150
    ds_read_b64_tr_b16 v[134:135], v150 offset:2048
    ds_read_b128 v[192:195], v142
    ds_read_b128 v[196:199], v142 offset:16
    ds_read_b128 v[160:163], v143
    s_waitcnt lgkmcnt(0)
    v_mfma_f32_16x16x32_bf16 v[180:183], v[128:131], v[160:163], 0
    v_mfma_f32_16x16x32_bf16 v[188:191], v[132:135], v[160:163], 0
    v_lshlrev_b32 v164, 16, v128
    v_and_b32 v165, v1, v128
    v_mul_f32 v164, v164, v192
    v_mul_f32 v165, v165, v193
    v_cvt_pk_bf16_f32 v168, v164, v165
    v_lshlrev_b32 v166, 16, v129
    v_and_b32 v167, v1, v129
    v_mul_f32 v166, v166, v194
    v_mul_f32 v167, v167, v195
    v_cvt_pk_bf16_f32 v169, v166, v167
    v_lshlrev_b32 v164, 16, v130
    v_and_b32 v165, v1, v130
    v_mul_f32 v164, v164, v196
    v_mul_f32 v165, v165, v197
    v_cvt_pk_bf16_f32 v170, v164, v165
    v_lshlrev_b32 v166, 16, v131
    v_and_b32 v167, v1, v131
    v_mul_f32 v166, v166, v198
    v_mul_f32 v167, v167, v199
    v_cvt_pk_bf16_f32 v171, v166, v167
    v_lshlrev_b32 v164, 16, v132
    v_and_b32 v165, v1, v132
    v_mul_f32 v164, v164, v192
    v_mul_f32 v165, v165, v193
    v_cvt_pk_bf16_f32 v172, v164, v165
    v_lshlrev_b32 v166, 16, v133
    v_and_b32 v167, v1, v133
    v_mul_f32 v166, v166, v194
    v_mul_f32 v167, v167, v195
    v_cvt_pk_bf16_f32 v173, v166, v167
    v_lshlrev_b32 v164, 16, v134
    v_and_b32 v165, v1, v134
    v_mul_f32 v164, v164, v196
    v_mul_f32 v165, v165, v197
    v_cvt_pk_bf16_f32 v174, v164, v165
    v_lshlrev_b32 v166, 16, v135
    v_and_b32 v167, v1, v135
    v_mul_f32 v166, v166, v198
    v_mul_f32 v167, v167, v199
    v_cvt_pk_bf16_f32 v175, v166, v167
    global_store_dwordx4 v140, v[168:171], s[4:5] sc1
    global_store_dwordx4 v140, v[172:175], s[4:5] offset:1024 sc1
    v_mfma_f32_16x16x32_bf16 v[176:179], v[168:171], v[144:147], 0
    v_mfma_f32_16x16x32_bf16 v[184:187], v[172:175], v[144:147], 0
    s_nop 6
    v_cndmask_b32 v192, v176, v180, s[28:29]
    v_cndmask_b32 v192, v192, v184, s[30:31]
    v_cndmask_b32 v192, v192, v188, s[32:33]
    v_cndmask_b32 v193, v177, v181, s[28:29]
    v_cndmask_b32 v193, v193, v185, s[30:31]
    v_cndmask_b32 v193, v193, v189, s[32:33]
    v_cndmask_b32 v194, v178, v182, s[28:29]
    v_cndmask_b32 v194, v194, v186, s[30:31]
    v_cndmask_b32 v194, v194, v190, s[32:33]
    v_cndmask_b32 v195, v179, v183, s[28:29]
    v_cndmask_b32 v195, v195, v187, s[30:31]
    v_cndmask_b32 v195, v195, v191, s[32:33]
    s_mov_b32 exec_lo, 0x000f000f
    s_mov_b32 exec_hi, 0x000f000f
    global_store_dwordx4 v141, v[192:195], s[4:5] sc1
    s_mov_b64 exec, -1
    s_branch L_cva
L_noprep2:
    global_load_dword v125, v124, s[4:5] sc1
L_cva:
    s_waitcnt lgkmcnt(0)
    s_barrier
    ds_read_b64 v[34:35], v39 offset:0
    ds_read_b128 v[16:19], v38 offset:0
    ds_read_b128 v[20:23], v38 offset:1024
    ds_read_b128 v[24:27], v38 offset:2048
    ds_read_b128 v[28:31], v38 offset:3072
    v_lshlrev_b32 v40, 16, v32
    v_and_b32 v41, v1, v32
    v_lshlrev_b32 v42, 16, v33
    v_and_b32 v43, v1, v33
    s_waitcnt lgkmcnt(4)
    v_lshlrev_b32 v44, 16, v34
    v_and_b32 v45, v1, v34
    v_lshlrev_b32 v46, 16, v35
    v_and_b32 v47, v1, v35
    s_waitcnt lgkmcnt(2)
    v_add_f32 v16, v16, v20
    v_add_f32 v17, v17, v21
    v_add_f32 v18, v18, v22
    v_add_f32 v19, v19, v23
    s_waitcnt lgkmcnt(0)
    v_add_f32 v24, v24, v28
    v_add_f32 v25, v25, v29
    v_add_f32 v26, v26, v30
    v_add_f32 v27, v27, v31
    v_fmac_f32 v16, v40, v53
    v_fmac_f32 v17, v41, v53
    v_fmac_f32 v18, v42, v53
    v_fmac_f32 v19, v43, v53
    v_add_f32 v16, v16, v24
    v_add_f32 v17, v17, v25
    v_add_f32 v18, v18, v26
    v_add_f32 v19, v19, v27
    v_fma_f32 v16, v16, v52, v44
    v_fma_f32 v17, v17, v52, v45
    v_fma_f32 v18, v18, v52, v46
    v_fma_f32 v19, v19, v52, v47
    v_cvt_pk_bf16_f32 v48, v16, v17
    v_cvt_pk_bf16_f32 v49, v18, v19
    global_store_dwordx2 v8, v[48:49], s[4:5] sc1
    v_add_u32 v8, 1081344, v8
    s_cmp_ge_u32 s3, 4
    s_cbranch_scc1 L_set1_1
    v_mfma_f32_16x16x32_bf16 v[16:19], v[56:59], v[116:119], 0
    ds_read_b64 v[192:193], v5 offset:20224
    ds_read_b64 v[194:195], v5 offset:20232
    v_mfma_f32_16x16x32_bf16 v[20:23], v[56:59], v[112:115], 0
    ds_read_b128 v[252:255], v0 offset:8192
    ds_read_b128 v[248:251], v0 offset:7680
    v_mfma_f32_16x16x32_bf16 v[24:27], v[56:59], v[92:95], 0
    ds_read_b128 v[228:231], v0 offset:5120
    ds_read_b128 v[224:227], v0 offset:4608
    v_mfma_f32_16x16x32_bf16 v[28:31], v[56:59], v[88:91], 0
    ds_read_b64 v[196:197], v5 offset:19712
    ds_read_b64 v[198:199], v5 offset:19720
    v_mfma_f32_16x16x32_bf16 v[16:19], v[60:63], v[112:115], v[16:19]
    ds_read_b128 v[244:247], v0 offset:7168
    ds_read_b64 v[200:201], v5 offset:19200
    v_mfma_f32_16x16x32_bf16 v[20:23], v[60:63], v[108:111], v[20:23]
    ds_read_b64 v[202:203], v5 offset:19208
    ds_read_b128 v[240:243], v0 offset:6656
    v_mfma_f32_16x16x32_bf16 v[24:27], v[60:63], v[88:91], v[24:27]
    ds_read_b64 v[204:205], v5 offset:18688
    ds_read_b64 v[206:207], v5 offset:18696
    v_mfma_f32_16x16x32_bf16 v[16:19], v[64:67], v[108:111], v[16:19]
    ds_read_b128 v[236:239], v0 offset:6144
    ds_read_b64 v[208:209], v5 offset:18176
    v_mfma_f32_16x16x32_bf16 v[20:23], v[64:67], v[104:107], v[20:23]
    ds_read_b64 v[210:211], v5 offset:18184
    ds_read_b128 v[232:235], v0 offset:5632
    v_mfma_f32_16x16x32_bf16 v[16:19], v[68:71], v[104:107], v[16:19]
    ds_read_b64 v[212:213], v5 offset:17664
    ds_read_b64 v[214:215], v5 offset:17672
    v_mfma_f32_16x16x32_bf16 v[20:23], v[68:71], v[100:103], v[20:23]
    ds_read_b64 v[216:217], v5 offset:17152
    ds_read_b64 v[218:219], v5 offset:17160
    v_mfma_f32_16x16x32_bf16 v[16:19], v[72:75], v[100:103], v[16:19]
    ds_read_b64 v[220:221], v5 offset:16640
    ds_read_b64 v[222:223], v5 offset:16648
    v_mfma_f32_16x16x32_bf16 v[20:23], v[72:75], v[96:99], v[20:23]
    v_mfma_f32_16x16x32_bf16 v[16:19], v[76:79], v[96:99], v[16:19]
    v_mfma_f32_16x16x32_bf16 v[20:23], v[76:79], v[92:95], v[20:23]
    v_mfma_f32_16x16x32_bf16 v[16:19], v[80:83], v[92:95], v[16:19]
    v_mfma_f32_16x16x32_bf16 v[20:23], v[80:83], v[88:91], v[20:23]
    v_mfma_f32_16x16x32_bf16 v[16:19], v[84:87], v[88:91], v[16:19]
    s_waitcnt lgkmcnt(0)
    v_mfma_f32_16x16x32_bf16 v[16:19], v[192:195], v[252:255], v[16:19]
    v_mfma_f32_16x16x32_bf16 v[20:23], v[192:195], v[248:251], v[20:23]
    v_mfma_f32_16x16x32_bf16 v[24:27], v[192:195], v[228:231], v[24:27]
    v_mfma_f32_16x16x32_bf16 v[28:31], v[192:195], v[224:227], v[28:31]
    v_mfma_f32_16x16x32_bf16 v[16:19], v[196:199], v[248:251], v[16:19]
    v_mfma_f32_16x16x32_bf16 v[20:23], v[196:199], v[244:247], v[20:23]
    v_mfma_f32_16x16x32_bf16 v[24:27], v[196:199], v[224:227], v[24:27]
    v_mfma_f32_16x16x32_bf16 v[16:19], v[200:203], v[244:247], v[16:19]
    v_mfma_f32_16x16x32_bf16 v[20:23], v[200:203], v[240:243], v[20:23]
    v_mfma_f32_16x16x32_bf16 v[16:19], v[204:207], v[240:243], v[16:19]
    v_mfma_f32_16x16x32_bf16 v[20:23], v[204:207], v[236:239], v[20:23]
    v_mfma_f32_16x16x32_bf16 v[16:19], v[208:211], v[236:239], v[16:19]
    v_mfma_f32_16x16x32_bf16 v[20:23], v[208:211], v[232:235], v[20:23]
    v_mfma_f32_16x16x32_bf16 v[16:19], v[212:215], v[232:235], v[16:19]
    v_mfma_f32_16x16x32_bf16 v[20:23], v[212:215], v[228:231], v[20:23]
    v_mfma_f32_16x16x32_bf16 v[16:19], v[216:219], v[228:231], v[16:19]
    v_mfma_f32_16x16x32_bf16 v[20:23], v[216:219], v[224:227], v[20:23]
    v_mfma_f32_16x16x32_bf16 v[16:19], v[220:223], v[224:227], v[16:19]
    v_mov_b32 v10, 151488
    v_mov_b32 v6, 1
    s_waitcnt vmcnt(0)
    s_mov_b64 exec, 1
    ds_add_rtn_u32 v6, v10, v6
    s_mov_b64 exec, -1
    s_lshl_b32 s54, s2, 7
    s_add_u32 s54, s54, 24248320
    s_waitcnt lgkmcnt(0)
    v_readfirstlane_b32 s55, v6
    s_nop 1
    s_cmp_lg_u32 s55, 7
    s_cbranch_scc1 L_afc
    v_lshl_add_u32 v10, v2, 2, s54
    s_mov_b64 exec, 0xffffffff
    global_store_dword v10, v15, s[4:5] sc1
    s_mov_b64 exec, -1
L_afc:
    s_branch L_conv_done1
L_set1_1:
    s_waitcnt vmcnt(1)
    s_mov_b32 s61, 0x40000
L_wf_poll:
    v_cmp_ne_u32 vcc, s60, v125
    s_cbranch_vccz L_wf_ok
    s_sleep 1
    global_load_dword v125, v124, s[4:5] sc1
    s_waitcnt vmcnt(0)
    s_sub_u32 s61, s61, 1
    s_cbranch_scc0 L_wf_poll
L_wf_ok:
    v_mfma_f32_16x16x32_bf16 v[16:19], v[56:59], v[108:111], 0
    ds_read_b64 v[192:193], v5 offset:20224
    ds_read_b64 v[194:195], v5 offset:20232
    buffer_load_dwordx4 v[128:131], v12, s[44:47], s40 offen offset:0 sc1
    v_mfma_f32_16x16x32_bf16 v[20:23], v[56:59], v[104:107], 0
    ds_read_b128 v[244:247], v0 offset:7168
    ds_read_b128 v[240:243], v0 offset:6656
    v_mfma_f32_16x16x32_bf16 v[24:27], v[56:59], v[100:103], 0
    ds_read_b128 v[236:239], v0 offset:6144
    ds_read_b128 v[232:235], v0 offset:5632
    buffer_load_dwordx4 v[132:135], v12, s[44:47], s41 offen offset:0 sc1
    v_mfma_f32_16x16x32_bf16 v[28:31], v[56:59], v[96:99], 0
    ds_read_b64 v[196:197], v5 offset:19712
    ds_read_b64 v[198:199], v5 offset:19720
    v_mfma_f32_16x16x32_bf16 v[16:19], v[60:63], v[104:107], v[16:19]
    ds_read_b128 v[228:231], v0 offset:5120
    ds_read_b64 v[200:201], v5 offset:19200
    buffer_load_dwordx4 v[136:139], v12, s[44:47], s42 offen offset:0 sc1
    v_mfma_f32_16x16x32_bf16 v[20:23], v[60:63], v[100:103], v[20:23]
    ds_read_b64 v[202:203], v5 offset:19208
    ds_read_b128 v[224:227], v0 offset:4608
    v_mfma_f32_16x16x32_bf16 v[24:27], v[60:63], v[96:99], v[24:27]
    ds_read_b64 v[204:205], v5 offset:18688
    ds_read_b64 v[206:207], v5 offset:18696
    buffer_load_dwordx4 v[140:143], v12, s[44:47], s43 offen offset:0 sc1
    v_mfma_f32_16x16x32_bf16 v[28:31], v[60:63], v[92:95], v[28:31]
    ds_read_b64 v[208:209], v5 offset:18176
    ds_read_b64 v[210:211], v5 offset:18184
    v_mfma_f32_16x16x32_bf16 v[16:19], v[64:67], v[100:103], v[16:19]
    ds_read_b64 v[212:213], v5 offset:17664
    ds_read_b64 v[214:215], v5 offset:17672
    buffer_load_dwordx3 v[144:146], v126, s[44:47], s40 offen offset:1024 sc1
    v_mfma_f32_16x16x32_bf16 v[20:23], v[64:67], v[96:99], v[20:23]
    v_mfma_f32_16x16x32_bf16 v[24:27], v[64:67], v[92:95], v[24:27]
    buffer_load_dwordx3 v[148:150], v126, s[44:47], s41 offen offset:1024 sc1
    v_mfma_f32_16x16x32_bf16 v[28:31], v[64:67], v[88:91], v[28:31]
    v_mfma_f32_16x16x32_bf16 v[16:19], v[68:71], v[96:99], v[16:19]
    buffer_load_dwordx3 v[152:154], v126, s[44:47], s42 offen offset:1024 sc1
    v_mfma_f32_16x16x32_bf16 v[20:23], v[68:71], v[92:95], v[20:23]
    v_mfma_f32_16x16x32_bf16 v[24:27], v[68:71], v[88:91], v[24:27]
    buffer_load_dwordx3 v[156:158], v126, s[44:47], s43 offen offset:1024 sc1
    v_mfma_f32_16x16x32_bf16 v[16:19], v[72:75], v[92:95], v[16:19]
    v_mfma_f32_16x16x32_bf16 v[20:23], v[72:75], v[88:91], v[20:23]
    buffer_load_dwordx4 v[160:163], v12, s[44:47], s40 offen offset:1792 sc1
    v_mfma_f32_16x16x32_bf16 v[16:19], v[76:79], v[88:91], v[16:19]
    s_waitcnt lgkmcnt(0)
    v_mov_b32 v10, 151488
    v_mov_b32 v6, 1
    s_waitcnt vmcnt(9)
    s_mov_b64 exec, 1
    ds_add_rtn_u32 v6, v10, v6
    s_mov_b64 exec, -1
    s_lshl_b32 s54, s2, 7
    s_add_u32 s54, s54, 24248320
    s_waitcnt lgkmcnt(0)
    v_readfirstlane_b32 s55, v6
    s_nop 1
    s_cmp_lg_u32 s55, 7
    s_cbranch_scc1 L_afh
    v_lshl_add_u32 v10, v2, 2, s54
    s_mov_b64 exec, 0xffffffff
    global_store_dword v10, v15, s[4:5] sc1
    s_mov_b64 exec, -1
L_afh:
    v_mfma_f32_16x16x32_bf16 v[16:19], v[192:195], v[244:247], v[16:19]
    buffer_load_dwordx4 v[164:167], v12, s[44:47], s41 offen offset:1792 sc1
    v_mfma_f32_16x16x32_bf16 v[20:23], v[192:195], v[240:243], v[20:23]
    v_mfma_f32_16x16x32_bf16 v[24:27], v[192:195], v[236:239], v[24:27]
    buffer_load_dwordx4 v[168:171], v12, s[44:47], s42 offen offset:1792 sc1
    v_mfma_f32_16x16x32_bf16 v[28:31], v[192:195], v[232:235], v[28:31]
    v_mfma_f32_16x16x32_bf16 v[16:19], v[196:199], v[240:243], v[16:19]
    buffer_load_dwordx4 v[172:175], v12, s[44:47], s43 offen offset:1792 sc1
    v_mfma_f32_16x16x32_bf16 v[20:23], v[196:199], v[236:239], v[20:23]
    v_mfma_f32_16x16x32_bf16 v[24:27], v[196:199], v[232:235], v[24:27]
    buffer_load_dwordx3 v[176:178], v126, s[44:47], s40 offen offset:2816 sc1
    v_mfma_f32_16x16x32_bf16 v[28:31], v[196:199], v[228:231], v[28:31]
    v_mfma_f32_16x16x32_bf16 v[16:19], v[200:203], v[236:239], v[16:19]
    buffer_load_dwordx3 v[180:182], v126, s[44:47], s41 offen offset:2816 sc1
    v_mfma_f32_16x16x32_bf16 v[20:23], v[200:203], v[232:235], v[20:23]
    v_mfma_f32_16x16x32_bf16 v[24:27], v[200:203], v[228:231], v[24:27]
    buffer_load_dwordx3 v[184:186], v126, s[44:47], s42 offen offset:2816 sc1
    v_mfma_f32_16x16x32_bf16 v[28:31], v[200:203], v[224:227], v[28:31]
    v_mfma_f32_16x16x32_bf16 v[16:19], v[204:207], v[232:235], v[16:19]
    buffer_load_dwordx3 v[188:190], v126, s[44:47], s43 offen offset:2816 sc1
    v_mfma_f32_16x16x32_bf16 v[20:23], v[204:207], v[228:231], v[20:23]
    v_mfma_f32_16x16x32_bf16 v[24:27], v[204:207], v[224:227], v[24:27]
    v_mfma_f32_16x16x32_bf16 v[16:19], v[208:211], v[228:231], v[16:19]
    v_mfma_f32_16x16x32_bf16 v[20:23], v[208:211], v[224:227], v[20:23]
    v_mfma_f32_16x16x32_bf16 v[16:19], v[212:215], v[224:227], v[16:19]
L_conv_done1:
    s_nop 5
    ds_read_b64 v[32:33], v7 offset:4608
    s_nop 0
    ds_write_b128 v14, v[16:19] offset:32768
    ds_write_b128 v14, v[20:23] offset:36864
    ds_write_b128 v14, v[24:27] offset:40960
    ds_write_b128 v14, v[28:31] offset:45056
    s_waitcnt lgkmcnt(0)
    s_barrier
    ds_read_b64 v[34:35], v39 offset:4096
    ds_read_b128 v[16:19], v38 offset:32768
    ds_read_b128 v[20:23], v38 offset:33792
    ds_read_b128 v[24:27], v38 offset:34816
    ds_read_b128 v[28:31], v38 offset:35840
    v_lshlrev_b32 v40, 16, v32
    v_and_b32 v41, v1, v32
    v_lshlrev_b32 v42, 16, v33
    v_and_b32 v43, v1, v33
    s_waitcnt lgkmcnt(4)
    v_lshlrev_b32 v44, 16, v34
    v_and_b32 v45, v1, v34
    v_lshlrev_b32 v46, 16, v35
    v_and_b32 v47, v1, v35
    s_waitcnt lgkmcnt(2)
    v_add_f32 v16, v16, v20
    v_add_f32 v17, v17, v21
    v_add_f32 v18, v18, v22
    v_add_f32 v19, v19, v23
    s_waitcnt lgkmcnt(0)
    s_barrier
    v_add_f32 v24, v24, v28
    v_add_f32 v25, v25, v29
    v_add_f32 v26, v26, v30
    v_add_f32 v27, v27, v31
    v_fmac_f32 v16, v40, v55
    v_fmac_f32 v17, v41, v55
    v_fmac_f32 v18, v42, v55
    v_fmac_f32 v19, v43, v55
    v_add_f32 v16, v16, v24
    v_add_f32 v17, v17, v25
    v_add_f32 v18, v18, v26
    v_add_f32 v19, v19, v27
    v_fma_f32 v16, v16, v54, v44
    v_fma_f32 v17, v17, v54, v45
    v_fma_f32 v18, v18, v54, v46
    v_fma_f32 v19, v19, v54, v47
    v_cvt_pk_bf16_f32 v48, v16, v17
    v_cvt_pk_bf16_f32 v49, v18, v19
    global_store_dwordx2 v8, v[48:49], s[4:5] sc1
    s_bfe_u32 s17, s2, 0x20001
    s_lshl_b32 s17, s17, 2
    s_lshr_b32 s18, s2, 6
    s_add_u32 s17, s17, s18
    s_sub_u32 s18, s3, 4
    s_mul_i32 s19, s17, 229376
    s_mul_i32 s20, s18, 7168
    s_add_u32 s26, s4, s19
    s_addc_u32 s27, s5, 0
    s_add_u32 s32, s26, 8388608
    s_addc_u32 s33, s27, 0
    s_mov_b32 s34, 229376
    s_mov_b32 s35, 0x20000
L_g_common:
    s_and_b32 s16, s2, 1
    s_lshl_b32 s16, s16, 3
    s_bfe_u32 s21, s2, 196611
    s_add_u32 s16, s16, s21
    v_mul_u32_u24 v15, 12, v2
    s_add_u32 s8, s4, 14680064
    s_addc_u32 s9, s5, 0
    s_mov_b32 s10, 7340032
    s_mov_b32 s11, 0x20000
    s_cmp_ge_u32 s3, 4
    s_cbranch_scc1 L_g_loader
    s_and_b32 s18, s3, 1
    s_lshr_b32 s19, s3, 1
    s_mul_i32 s20, s18, 7168
    v_add_u32 v5, s20, v12
    v_bfe_u32 v6, v2, 2, 2
    v_and_b32 v7, 1, v4
    v_lshl_or_b32 v7, v7, 2, v6
    s_lshl_b32 s21, s19, 2
    v_xor_b32 v7, s21, v7
    v_lshlrev_b32 v7, 5, v7
    v_lshl_add_u32 v6, v4, 3, v6
    v_lshl_add_u32 v6, v6, 8, v7
    v_and_b32 v7, 3, v2
    v_lshl_add_u32 v6, v7, 3, v6
    v_add_u32 v6, 28672, v6
    v_xor_b32 v7, 32, v6
    v_xor_b32 v8, 64, v6
    v_xor_b32 v9, 96, v6
    v_add_u32 v116, 45056, v5
    v_add_u32 v117, 45056, v6
    v_add_u32 v118, 45056, v7
    v_add_u32 v119, 45056, v8
    v_add_u32 v120, 45056, v9
    v_add_u32 v121, 90112, v5
    v_add_u32 v122, 90112, v6
    v_add_u32 v123, 90112, v7
    v_add_u32 v124, 90112, v8
    v_add_u32 v125, 90112, v9
    s_lshl_b32 s29, s21, 7
    v_lshl_add_u32 v10, v3, 3, s29
    v_xor_b32 v13, 256, v10
    v_lshrrev_b32 v14, 5, v2
    v_lshl_add_u32 v14, v14, 7, v10
    v_add_u32 v10, 162816, v10
    v_add_u32 v13, 162816, v13
    v_add_u32 v14, 162816, v14
    s_mul_i32 s29, s18, 896
    s_add_u32 s29, s29, 160768
    v_lshl_add_u32 v11, v4, 4, s29
    v_mov_b32 v1, 0xffff0000
    s_lshl_b32 s22, s17, 1
    s_add_u32 s22, s22, s18
    s_mul_i32 s22, s22, 1792
    s_lshl_b32 s23, s16, 3
    s_xor_b32 s29, s21, 0
    s_add_u32 s29, s29, s23
    s_mul_i32 s29, s29, 57344
    s_add_u32 s32, s29, s22
    s_xor_b32 s29, s21, 1
    s_add_u32 s29, s29, s23
    s_mul_i32 s29, s29, 57344
    s_add_u32 s33, s29, s22
    s_xor_b32 s29, s21, 2
    s_add_u32 s29, s29, s23
    s_mul_i32 s29, s29, 57344
    s_add_u32 s34, s29, s22
    s_xor_b32 s29, s21, 3
    s_add_u32 s29, s29, s23
    s_mul_i32 s29, s29, 57344
    s_add_u32 s35, s29, s22
    v_mov_b32 v104, 0
    v_mov_b32 v105, 0
    v_mov_b32 v106, 0
    v_mov_b32 v107, 0
    v_mov_b32 v108, 0
    v_mov_b32 v109, 0
    v_mov_b32 v110, 0
    v_mov_b32 v111, 0
    v_mov_b32 v126, 160000
    v_mov_b32 v99, 0
    ds_write2_b32 v126, v99, v99 offset1:1
    ds_write2_b32 v126, v99, v99 offset0:2 offset1:3
    ds_write2_b32 v126, v99, v99 offset0:4 offset1:5
    ds_write2_b32 v126, v99, v99 offset0:6 offset1:7
    ds_write_b32 v126, v99 offset:32
    v_mov_b32 v126, s60
    s_cmp_lg_u32 s3, 0
    s_cbranch_scc1 L_g_s2done
    v_and_b32 v127, 31, v2
    v_lshrrev_b32 v100, 5, v2
    v_lshl_add_u32 v127, v127, 3, v100
    v_lshlrev_b32 v127, 7, v127
    v_add_u32 v127, 24248320, v127
    s_mov_b32 s61, 0x40000
L_s2a_poll:
    s_sleep 3
    global_load_dword v100, v127, s[4:5] sc1
    global_load_dword v101, v127, s[4:5] offset:256 sc1
    global_load_dword v102, v127, s[4:5] offset:512 sc1
    global_load_dword v103, v127, s[4:5] offset:768 sc1
L_s2a_chk:
    s_waitcnt vmcnt(0)
    v_xor_b32 v100, v126, v100
    v_xor_b32 v101, v126, v101
    v_xor_b32 v102, v126, v102
    v_xor_b32 v103, v126, v103
    v_or3_b32 v100, v100, v101, v102
    v_or_b32 v100, v100, v103
    v_cmp_ne_u32 vcc, 0, v100
    s_cbranch_vccz L_s2a_ok
    s_nop 0
    s_mov_b64 exec, vcc
    s_sub_u32 s61, s61, 1
    s_cbranch_scc0 L_s2a_poll
L_s2a_ok:
    s_mov_b64 exec, -1
    s_barrier
    s_cmp_lg_u32 s2, 0
    s_cbranch_scc1 L_g_s2b
    s_mov_b32 s29, 24117248
    v_mov_b32 v100, s62
    v_lshl_add_u32 v127, v2, 2, s29
    s_mov_b64 exec, 0xffffffff
    global_store_dword v127, v100, s[4:5] sc1
    s_mov_b64 exec, -1
    s_branch L_g_s2b
L_g_s2done:
    s_lshl_b32 s29, s2, 7
    s_add_u32 s29, s29, 24182784
    s_waitcnt vmcnt(0)
    s_barrier
    s_cmp_lg_u32 s3, 1
    s_cbranch_scc1 L_g_nob
    v_lshl_add_u32 v127, v2, 2, s29
    s_mov_b64 exec, 0xffffffff
    global_store_dword v127, v126, s[4:5] sc1
    s_mov_b64 exec, -1
L_g_nob:
L_g_s2b:
    s_barrier
    ds_read_b64_tr_b16 v[44:45], v6 offset:0
    ds_read_b64_tr_b16 v[46:47], v6 offset:1024
    ds_read_b128 v[16:19], v5 offset:0
    ds_read_b64_tr_b16 v[48:49], v7 offset:0
    ds_read_b64_tr_b16 v[50:51], v7 offset:1024
    ds_read_b128 v[20:23], v5 offset:1024
    ds_read_b64_tr_b16 v[52:53], v8 offset:0
    ds_read_b64_tr_b16 v[54:55], v8 offset:1024
    ds_read_b128 v[24:27], v5 offset:2048
    ds_read_b64_tr_b16 v[56:57], v9 offset:0
    ds_read_b64_tr_b16 v[58:59], v9 offset:1024
    ds_read_b128 v[28:31], v5 offset:3072
    ds_read_b128 v[32:35], v5 offset:4096
    ds_read_b128 v[36:39], v5 offset:5120
    ds_read_b128 v[40:43], v5 offset:6144
    s_waitcnt lgkmcnt(0)
    v_mfma_f32_16x16x32_bf16 v[128:131], v[16:19], v[44:47], 0
    ds_read_b64_tr_b16 v[88:89], v6 offset:8192
    v_mfma_f32_16x16x32_bf16 v[132:135], v[16:19], v[48:51], 0
    ds_read_b64_tr_b16 v[90:91], v6 offset:9216
    v_mfma_f32_16x16x32_bf16 v[136:139], v[16:19], v[52:55], 0
    ds_read_b128 v[60:63], v5 offset:14336
    v_mfma_f32_16x16x32_bf16 v[140:143], v[16:19], v[56:59], 0
    ds_read_b64_tr_b16 v[92:93], v7 offset:8192
    v_mfma_f32_16x16x32_bf16 v[144:147], v[20:23], v[44:47], 0
    ds_read_b64_tr_b16 v[94:95], v7 offset:9216
    v_mfma_f32_16x16x32_bf16 v[148:151], v[20:23], v[48:51], 0
    ds_read_b128 v[64:67], v5 offset:15360
    v_mfma_f32_16x16x32_bf16 v[152:155], v[20:23], v[52:55], 0
    ds_read_b64_tr_b16 v[96:97], v8 offset:8192
    v_mfma_f32_16x16x32_bf16 v[156:159], v[20:23], v[56:59], 0
    ds_read_b64_tr_b16 v[98:99], v8 offset:9216
    v_mfma_f32_16x16x32_bf16 v[160:163], v[24:27], v[44:47], 0
    ds_read_b128 v[68:71], v5 offset:16384
    v_mfma_f32_16x16x32_bf16 v[164:167], v[24:27], v[48:51], 0
    ds_read_b64_tr_b16 v[100:101], v9 offset:8192
    v_mfma_f32_16x16x32_bf16 v[168:171], v[24:27], v[52:55], 0
    ds_read_b64_tr_b16 v[102:103], v9 offset:9216
    v_mfma_f32_16x16x32_bf16 v[172:175], v[24:27], v[56:59], 0
    ds_read_b128 v[72:75], v5 offset:17408
    v_mfma_f32_16x16x32_bf16 v[176:179], v[28:31], v[44:47], 0
    ds_read_b128 v[76:79], v5 offset:18432
    v_mfma_f32_16x16x32_bf16 v[180:183], v[28:31], v[48:51], 0
    ds_read_b128 v[80:83], v5 offset:19456
    v_mfma_f32_16x16x32_bf16 v[184:187], v[28:31], v[52:55], 0
    ds_read_b128 v[84:87], v5 offset:20480
    v_mfma_f32_16x16x32_bf16 v[188:191], v[28:31], v[56:59], 0
    v_mfma_f32_16x16x32_bf16 v[192:195], v[32:35], v[44:47], 0
    v_mfma_f32_16x16x32_bf16 v[196:199], v[32:35], v[48:51], 0
    v_mfma_f32_16x16x32_bf16 v[200:203], v[32:35], v[52:55], 0
    v_mfma_f32_16x16x32_bf16 v[204:207], v[32:35], v[56:59], 0
    v_mfma_f32_16x16x32_bf16 v[208:211], v[36:39], v[44:47], 0
    v_mfma_f32_16x16x32_bf16 v[212:215], v[36:39], v[48:51], 0
    v_mfma_f32_16x16x32_bf16 v[216:219], v[36:39], v[52:55], 0
    v_mfma_f32_16x16x32_bf16 v[220:223], v[36:39], v[56:59], 0
    v_mfma_f32_16x16x32_bf16 v[224:227], v[40:43], v[44:47], 0
    v_mfma_f32_16x16x32_bf16 v[228:231], v[40:43], v[48:51], 0
    v_mfma_f32_16x16x32_bf16 v[232:235], v[40:43], v[52:55], 0
    v_mfma_f32_16x16x32_bf16 v[236:239], v[40:43], v[56:59], 0
    s_waitcnt lgkmcnt(0)
    s_barrier
    v_mfma_f32_16x16x32_bf16 v[128:131], v[60:63], v[88:91], v[128:131]
    ds_read_b64_tr_b16 v[44:45], v117 offset:0
    v_mfma_f32_16x16x32_bf16 v[132:135], v[60:63], v[92:95], v[132:135]
    ds_read_b64_tr_b16 v[46:47], v117 offset:1024
    v_mfma_f32_16x16x32_bf16 v[136:139], v[60:63], v[96:99], v[136:139]
    ds_read_b128 v[16:19], v116 offset:0
    v_mfma_f32_16x16x32_bf16 v[140:143], v[60:63], v[100:103], v[140:143]
    ds_read_b64_tr_b16 v[48:49], v118 offset:0
    v_mfma_f32_16x16x32_bf16 v[144:147], v[64:67], v[88:91], v[144:147]
    ds_read_b64_tr_b16 v[50:51], v118 offset:1024
    v_mfma_f32_16x16x32_bf16 v[148:151], v[64:67], v[92:95], v[148:151]
    ds_read_b128 v[20:23], v116 offset:1024
    v_mfma_f32_16x16x32_bf16 v[152:155], v[64:67], v[96:99], v[152:155]
    ds_read_b64_tr_b16 v[52:53], v119 offset:0
    v_mfma_f32_16x16x32_bf16 v[156:159], v[64:67], v[100:103], v[156:159]
    ds_read_b64_tr_b16 v[54:55], v119 offset:1024
    v_mfma_f32_16x16x32_bf16 v[160:163], v[68:71], v[88:91], v[160:163]
    ds_read_b128 v[24:27], v116 offset:2048
    v_mfma_f32_16x16x32_bf16 v[164:167], v[68:71], v[92:95], v[164:167]
    ds_read_b64_tr_b16 v[56:57], v120 offset:0
    v_mfma_f32_16x16x32_bf16 v[168:171], v[68:71], v[96:99], v[168:171]
    ds_read_b64_tr_b16 v[58:59], v120 offset:1024
    v_mfma_f32_16x16x32_bf16 v[172:175], v[68:71], v[100:103], v[172:175]
    ds_read_b128 v[28:31], v116 offset:3072
    v_mfma_f32_16x16x32_bf16 v[176:179], v[72:75], v[88:91], v[176:179]
    ds_read_b128 v[32:35], v116 offset:4096
    v_mfma_f32_16x16x32_bf16 v[180:183], v[72:75], v[92:95], v[180:183]
    ds_read_b128 v[36:39], v116 offset:5120
    v_mfma_f32_16x16x32_bf16 v[184:187], v[72:75], v[96:99], v[184:187]
    ds_read_b128 v[40:43], v116 offset:6144
    v_mfma_f32_16x16x32_bf16 v[188:191], v[72:75], v[100:103], v[188:191]
    v_mfma_f32_16x16x32_bf16 v[192:195], v[76:79], v[88:91], v[192:195]
    v_mfma_f32_16x16x32_bf16 v[196:199], v[76:79], v[92:95], v[196:199]
    v_mfma_f32_16x16x32_bf16 v[200:203], v[76:79], v[96:99], v[200:203]
    v_mfma_f32_16x16x32_bf16 v[204:207], v[76:79], v[100:103], v[204:207]
    v_mfma_f32_16x16x32_bf16 v[208:211], v[80:83], v[88:91], v[208:211]
    v_mfma_f32_16x16x32_bf16 v[212:215], v[80:83], v[92:95], v[212:215]
    v_mfma_f32_16x16x32_bf16 v[216:219], v[80:83], v[96:99], v[216:219]
    v_mfma_f32_16x16x32_bf16 v[220:223], v[80:83], v[100:103], v[220:223]
    v_mfma_f32_16x16x32_bf16 v[224:227], v[84:87], v[88:91], v[224:227]
    v_mfma_f32_16x16x32_bf16 v[228:231], v[84:87], v[92:95], v[228:231]
    v_mfma_f32_16x16x32_bf16 v[232:235], v[84:87], v[96:99], v[232:235]
    v_mfma_f32_16x16x32_bf16 v[236:239], v[84:87], v[100:103], v[236:239]
    s_waitcnt lgkmcnt(0)
    v_mfma_f32_16x16x32_bf16 v[128:131], v[16:19], v[44:47], v[128:131]
    ds_read_b64_tr_b16 v[88:89], v117 offset:8192
    v_mfma_f32_16x16x32_bf16 v[132:135], v[16:19], v[48:51], v[132:135]
    ds_read_b64_tr_b16 v[90:91], v117 offset:9216
    v_mfma_f32_16x16x32_bf16 v[136:139], v[16:19], v[52:55], v[136:139]
    ds_read_b128 v[60:63], v116 offset:14336
    v_mfma_f32_16x16x32_bf16 v[140:143], v[16:19], v[56:59], v[140:143]
    ds_read_b64_tr_b16 v[92:93], v118 offset:8192
    v_mfma_f32_16x16x32_bf16 v[144:147], v[20:23], v[44:47], v[144:147]
    ds_read_b64_tr_b16 v[94:95], v118 offset:9216
    v_mfma_f32_16x16x32_bf16 v[148:151], v[20:23], v[48:51], v[148:151]
    ds_read_b128 v[64:67], v116 offset:15360
    v_mfma_f32_16x16x32_bf16 v[152:155], v[20:23], v[52:55], v[152:155]
    ds_read_b64_tr_b16 v[96:97], v119 offset:8192
    v_mfma_f32_16x16x32_bf16 v[156:159], v[20:23], v[56:59], v[156:159]
    ds_read_b64_tr_b16 v[98:99], v119 offset:9216
    v_mfma_f32_16x16x32_bf16 v[160:163], v[24:27], v[44:47], v[160:163]
    ds_read_b128 v[68:71], v116 offset:16384
    v_mfma_f32_16x16x32_bf16 v[164:167], v[24:27], v[48:51], v[164:167]
    ds_read_b64_tr_b16 v[100:101], v120 offset:8192
    v_mfma_f32_16x16x32_bf16 v[168:171], v[24:27], v[52:55], v[168:171]
    ds_read_b64_tr_b16 v[102:103], v120 offset:9216
    v_mfma_f32_16x16x32_bf16 v[172:175], v[24:27], v[56:59], v[172:175]
    ds_read_b128 v[72:75], v116 offset:17408
    v_mfma_f32_16x16x32_bf16 v[176:179], v[28:31], v[44:47], v[176:179]
    ds_read_b128 v[76:79], v116 offset:18432
    v_mfma_f32_16x16x32_bf16 v[180:183], v[28:31], v[48:51], v[180:183]
    ds_read_b128 v[80:83], v116 offset:19456
    v_mfma_f32_16x16x32_bf16 v[184:187], v[28:31], v[52:55], v[184:187]
    ds_read_b128 v[84:87], v116 offset:20480
    v_mfma_f32_16x16x32_bf16 v[188:191], v[28:31], v[56:59], v[188:191]
    v_mfma_f32_16x16x32_bf16 v[192:195], v[32:35], v[44:47], v[192:195]
    v_mfma_f32_16x16x32_bf16 v[196:199], v[32:35], v[48:51], v[196:199]
    v_mfma_f32_16x16x32_bf16 v[200:203], v[32:35], v[52:55], v[200:203]
    v_mfma_f32_16x16x32_bf16 v[204:207], v[32:35], v[56:59], v[204:207]
    v_mfma_f32_16x16x32_bf16 v[208:211], v[36:39], v[44:47], v[208:211]
    v_mfma_f32_16x16x32_bf16 v[212:215], v[36:39], v[48:51], v[212:215]
    v_mfma_f32_16x16x32_bf16 v[216:219], v[36:39], v[52:55], v[216:219]
    v_mfma_f32_16x16x32_bf16 v[220:223], v[36:39], v[56:59], v[220:223]
    v_mfma_f32_16x16x32_bf16 v[224:227], v[40:43], v[44:47], v[224:227]
    v_mfma_f32_16x16x32_bf16 v[228:231], v[40:43], v[48:51], v[228:231]
    v_mfma_f32_16x16x32_bf16 v[232:235], v[40:43], v[52:55], v[232:235]
    v_mfma_f32_16x16x32_bf16 v[236:239], v[40:43], v[56:59], v[236:239]
    s_waitcnt lgkmcnt(0)
    s_barrier
    v_mfma_f32_16x16x32_bf16 v[128:131], v[60:63], v[88:91], v[128:131]
    ds_read_b64_tr_b16 v[44:45], v122 offset:0
    v_mfma_f32_16x16x32_bf16 v[132:135], v[60:63], v[92:95], v[132:135]
    ds_read_b64_tr_b16 v[46:47], v122 offset:1024
    v_mfma_f32_16x16x32_bf16 v[136:139], v[60:63], v[96:99], v[136:139]
    ds_read_b128 v[16:19], v121 offset:0
    v_mfma_f32_16x16x32_bf16 v[140:143], v[60:63], v[100:103], v[140:143]
    ds_read_b64_tr_b16 v[48:49], v123 offset:0
    v_mfma_f32_16x16x32_bf16 v[144:147], v[64:67], v[88:91], v[144:147]
    ds_read_b64_tr_b16 v[50:51], v123 offset:1024
    v_mfma_f32_16x16x32_bf16 v[148:151], v[64:67], v[92:95], v[148:151]
    ds_read_b128 v[20:23], v121 offset:1024
    v_mfma_f32_16x16x32_bf16 v[152:155], v[64:67], v[96:99], v[152:155]
    ds_read_b64_tr_b16 v[52:53], v124 offset:0
    v_mfma_f32_16x16x32_bf16 v[156:159], v[64:67], v[100:103], v[156:159]
    ds_read_b64_tr_b16 v[54:55], v124 offset:1024
    v_mfma_f32_16x16x32_bf16 v[160:163], v[68:71], v[88:91], v[160:163]
    ds_read_b128 v[24:27], v121 offset:2048
    v_mfma_f32_16x16x32_bf16 v[164:167], v[68:71], v[92:95], v[164:167]
    ds_read_b64_tr_b16 v[56:57], v125 offset:0
    v_mfma_f32_16x16x32_bf16 v[168:171], v[68:71], v[96:99], v[168:171]
    ds_read_b64_tr_b16 v[58:59], v125 offset:1024
    v_mfma_f32_16x16x32_bf16 v[172:175], v[68:71], v[100:103], v[172:175]
    ds_read_b128 v[28:31], v121 offset:3072
    v_mfma_f32_16x16x32_bf16 v[176:179], v[72:75], v[88:91], v[176:179]
    ds_read_b128 v[32:35], v121 offset:4096
    v_mfma_f32_16x16x32_bf16 v[180:183], v[72:75], v[92:95], v[180:183]
    ds_read_b128 v[36:39], v121 offset:5120
    v_mfma_f32_16x16x32_bf16 v[184:187], v[72:75], v[96:99], v[184:187]
    ds_read_b128 v[40:43], v121 offset:6144
    v_mfma_f32_16x16x32_bf16 v[188:191], v[72:75], v[100:103], v[188:191]
    v_mfma_f32_16x16x32_bf16 v[192:195], v[76:79], v[88:91], v[192:195]
    v_mfma_f32_16x16x32_bf16 v[196:199], v[76:79], v[92:95], v[196:199]
    v_mfma_f32_16x16x32_bf16 v[200:203], v[76:79], v[96:99], v[200:203]
    v_mfma_f32_16x16x32_bf16 v[204:207], v[76:79], v[100:103], v[204:207]
    v_mfma_f32_16x16x32_bf16 v[208:211], v[80:83], v[88:91], v[208:211]
    v_mfma_f32_16x16x32_bf16 v[212:215], v[80:83], v[92:95], v[212:215]
    v_mfma_f32_16x16x32_bf16 v[216:219], v[80:83], v[96:99], v[216:219]
    v_mfma_f32_16x16x32_bf16 v[220:223], v[80:83], v[100:103], v[220:223]
    v_mfma_f32_16x16x32_bf16 v[224:227], v[84:87], v[88:91], v[224:227]
    v_mfma_f32_16x16x32_bf16 v[228:231], v[84:87], v[92:95], v[228:231]
    v_mfma_f32_16x16x32_bf16 v[232:235], v[84:87], v[96:99], v[232:235]
    v_mfma_f32_16x16x32_bf16 v[236:239], v[84:87], v[100:103], v[236:239]
    s_waitcnt lgkmcnt(0)
    v_mfma_f32_16x16x32_bf16 v[128:131], v[16:19], v[44:47], v[128:131]
    ds_read_b64_tr_b16 v[88:89], v122 offset:8192
    v_mfma_f32_16x16x32_bf16 v[132:135], v[16:19], v[48:51], v[132:135]
    ds_read_b64_tr_b16 v[90:91], v122 offset:9216
    v_mfma_f32_16x16x32_bf16 v[136:139], v[16:19], v[52:55], v[136:139]
    ds_read_b128 v[60:63], v121 offset:14336
    v_mfma_f32_16x16x32_bf16 v[140:143], v[16:19], v[56:59], v[140:143]
    ds_read_b64_tr_b16 v[92:93], v123 offset:8192
    v_mfma_f32_16x16x32_bf16 v[144:147], v[20:23], v[44:47], v[144:147]
    ds_read_b64_tr_b16 v[94:95], v123 offset:9216
    v_mfma_f32_16x16x32_bf16 v[148:151], v[20:23], v[48:51], v[148:151]
    ds_read_b128 v[64:67], v121 offset:15360
    v_mfma_f32_16x16x32_bf16 v[152:155], v[20:23], v[52:55], v[152:155]
    ds_read_b64_tr_b16 v[96:97], v124 offset:8192
    v_mfma_f32_16x16x32_bf16 v[156:159], v[20:23], v[56:59], v[156:159]
    ds_read_b64_tr_b16 v[98:99], v124 offset:9216
    v_mfma_f32_16x16x32_bf16 v[160:163], v[24:27], v[44:47], v[160:163]
    ds_read_b128 v[68:71], v121 offset:16384
    v_mfma_f32_16x16x32_bf16 v[164:167], v[24:27], v[48:51], v[164:167]
    ds_read_b64_tr_b16 v[100:101], v125 offset:8192
    v_mfma_f32_16x16x32_bf16 v[168:171], v[24:27], v[52:55], v[168:171]
    ds_read_b64_tr_b16 v[102:103], v125 offset:9216
    v_mfma_f32_16x16x32_bf16 v[172:175], v[24:27], v[56:59], v[172:175]
    ds_read_b128 v[72:75], v121 offset:17408
    v_mfma_f32_16x16x32_bf16 v[176:179], v[28:31], v[44:47], v[176:179]
    ds_read_b128 v[76:79], v121 offset:18432
    v_mfma_f32_16x16x32_bf16 v[180:183], v[28:31], v[48:51], v[180:183]
    ds_read_b128 v[80:83], v121 offset:19456
    v_mfma_f32_16x16x32_bf16 v[184:187], v[28:31], v[52:55], v[184:187]
    ds_read_b128 v[84:87], v121 offset:20480
    v_mfma_f32_16x16x32_bf16 v[188:191], v[28:31], v[56:59], v[188:191]
    v_mfma_f32_16x16x32_bf16 v[192:195], v[32:35], v[44:47], v[192:195]
    v_mfma_f32_16x16x32_bf16 v[196:199], v[32:35], v[48:51], v[196:199]
    v_mfma_f32_16x16x32_bf16 v[200:203], v[32:35], v[52:55], v[200:203]
    v_mfma_f32_16x16x32_bf16 v[204:207], v[32:35], v[56:59], v[204:207]
    v_mfma_f32_16x16x32_bf16 v[208:211], v[36:39], v[44:47], v[208:211]
    v_mfma_f32_16x16x32_bf16 v[212:215], v[36:39], v[48:51], v[212:215]
    v_mfma_f32_16x16x32_bf16 v[216:219], v[36:39], v[52:55], v[216:219]
    v_mfma_f32_16x16x32_bf16 v[220:223], v[36:39], v[56:59], v[220:223]
    v_mfma_f32_16x16x32_bf16 v[224:227], v[40:43], v[44:47], v[224:227]
    v_mfma_f32_16x16x32_bf16 v[228:231], v[40:43], v[48:51], v[228:231]
    v_mfma_f32_16x16x32_bf16 v[232:235], v[40:43], v[52:55], v[232:235]
    v_mfma_f32_16x16x32_bf16 v[236:239], v[40:43], v[56:59], v[236:239]
    s_waitcnt lgkmcnt(0)
    s_barrier
    v_mfma_f32_16x16x32_bf16 v[128:131], v[60:63], v[88:91], v[128:131]
    ds_read_b64_tr_b16 v[44:45], v6 offset:0
    v_mfma_f32_16x16x32_bf16 v[132:135], v[60:63], v[92:95], v[132:135]
    ds_read_b64_tr_b16 v[46:47], v6 offset:1024
    v_mfma_f32_16x16x32_bf16 v[136:139], v[60:63], v[96:99], v[136:139]
    ds_read_b128 v[16:19], v5 offset:0
    v_mfma_f32_16x16x32_bf16 v[140:143], v[60:63], v[100:103], v[140:143]
    ds_read_b64_tr_b16 v[48:49], v7 offset:0
    v_mfma_f32_16x16x32_bf16 v[144:147], v[64:67], v[88:91], v[144:147]
    ds_read_b64_tr_b16 v[50:51], v7 offset:1024
    v_mfma_f32_16x16x32_bf16 v[148:151], v[64:67], v[92:95], v[148:151]
    ds_read_b128 v[20:23], v5 offset:1024
    v_mfma_f32_16x16x32_bf16 v[152:155], v[64:67], v[96:99], v[152:155]
    ds_read_b64_tr_b16 v[52:53], v8 offset:0
    v_mfma_f32_16x16x32_bf16 v[156:159], v[64:67], v[100:103], v[156:159]
    ds_read_b64_tr_b16 v[54:55], v8 offset:1024
    v_mfma_f32_16x16x32_bf16 v[160:163], v[68:71], v[88:91], v[160:163]
    ds_read_b128 v[24:27], v5 offset:2048
    v_mfma_f32_16x16x32_bf16 v[164:167], v[68:71], v[92:95], v[164:167]
    ds_read_b64_tr_b16 v[56:57], v9 offset:0
    v_mfma_f32_16x16x32_bf16 v[168:171], v[68:71], v[96:99], v[168:171]
    ds_read_b64_tr_b16 v[58:59], v9 offset:1024
    v_mfma_f32_16x16x32_bf16 v[172:175], v[68:71], v[100:103], v[172:175]
    ds_read_b128 v[28:31], v5 offset:3072
    v_mfma_f32_16x16x32_bf16 v[176:179], v[72:75], v[88:91], v[176:179]
    ds_read_b128 v[32:35], v5 offset:4096
    v_mfma_f32_16x16x32_bf16 v[180:183], v[72:75], v[92:95], v[180:183]
    ds_read_b128 v[36:39], v5 offset:5120
    v_mfma_f32_16x16x32_bf16 v[184:187], v[72:75], v[96:99], v[184:187]
    ds_read_b128 v[40:43], v5 offset:6144
    v_mfma_f32_16x16x32_bf16 v[188:191], v[72:75], v[100:103], v[188:191]
    v_mfma_f32_16x16x32_bf16 v[192:195], v[76:79], v[88:91], v[192:195]
    v_mfma_f32_16x16x32_bf16 v[196:199], v[76:79], v[92:95], v[196:199]
    v_mfma_f32_16x16x32_bf16 v[200:203], v[76:79], v[96:99], v[200:203]
    v_mfma_f32_16x16x32_bf16 v[204:207], v[76:79], v[100:103], v[204:207]
    v_mfma_f32_16x16x32_bf16 v[208:211], v[80:83], v[88:91], v[208:211]
    v_mfma_f32_16x16x32_bf16 v[212:215], v[80:83], v[92:95], v[212:215]
    v_mfma_f32_16x16x32_bf16 v[216:219], v[80:83], v[96:99], v[216:219]
    v_mfma_f32_16x16x32_bf16 v[220:223], v[80:83], v[100:103], v[220:223]
    v_mfma_f32_16x16x32_bf16 v[224:227], v[84:87], v[88:91], v[224:227]
    v_mfma_f32_16x16x32_bf16 v[228:231], v[84:87], v[92:95], v[228:231]
    v_mfma_f32_16x16x32_bf16 v[232:235], v[84:87], v[96:99], v[232:235]
    v_mfma_f32_16x16x32_bf16 v[236:239], v[84:87], v[100:103], v[236:239]
    s_waitcnt lgkmcnt(0)
    v_mfma_f32_16x16x32_bf16 v[128:131], v[16:19], v[44:47], v[128:131]
    ds_read_b64_tr_b16 v[88:89], v6 offset:8192
    v_mfma_f32_16x16x32_bf16 v[132:135], v[16:19], v[48:51], v[132:135]
    ds_read_b64_tr_b16 v[90:91], v6 offset:9216
    v_mfma_f32_16x16x32_bf16 v[136:139], v[16:19], v[52:55], v[136:139]
    ds_read_b128 v[60:63], v5 offset:14336
    v_mfma_f32_16x16x32_bf16 v[140:143], v[16:19], v[56:59], v[140:143]
    ds_read_b64_tr_b16 v[92:93], v7 offset:8192
    v_mfma_f32_16x16x32_bf16 v[144:147], v[20:23], v[44:47], v[144:147]
    ds_read_b64_tr_b16 v[94:95], v7 offset:9216
    v_mfma_f32_16x16x32_bf16 v[148:151], v[20:23], v[48:51], v[148:151]
    ds_read_b128 v[64:67], v5 offset:15360
    v_mfma_f32_16x16x32_bf16 v[152:155], v[20:23], v[52:55], v[152:155]
    ds_read_b64_tr_b16 v[96:97], v8 offset:8192
    v_mfma_f32_16x16x32_bf16 v[156:159], v[20:23], v[56:59], v[156:159]
    ds_read_b64_tr_b16 v[98:99], v8 offset:9216
    v_mfma_f32_16x16x32_bf16 v[160:163], v[24:27], v[44:47], v[160:163]
    ds_read_b128 v[68:71], v5 offset:16384
    v_mfma_f32_16x16x32_bf16 v[164:167], v[24:27], v[48:51], v[164:167]
    ds_read_b64_tr_b16 v[100:101], v9 offset:8192
    v_mfma_f32_16x16x32_bf16 v[168:171], v[24:27], v[52:55], v[168:171]
    ds_read_b64_tr_b16 v[102:103], v9 offset:9216
    v_mfma_f32_16x16x32_bf16 v[172:175], v[24:27], v[56:59], v[172:175]
    ds_read_b128 v[72:75], v5 offset:17408
    v_mfma_f32_16x16x32_bf16 v[176:179], v[28:31], v[44:47], v[176:179]
    ds_read_b128 v[76:79], v5 offset:18432
    v_mfma_f32_16x16x32_bf16 v[180:183], v[28:31], v[48:51], v[180:183]
    ds_read_b128 v[80:83], v5 offset:19456
    v_mfma_f32_16x16x32_bf16 v[184:187], v[28:31], v[52:55], v[184:187]
    ds_read_b128 v[84:87], v5 offset:20480
    v_mfma_f32_16x16x32_bf16 v[188:191], v[28:31], v[56:59], v[188:191]
    v_mfma_f32_16x16x32_bf16 v[192:195], v[32:35], v[44:47], v[192:195]
    v_mfma_f32_16x16x32_bf16 v[196:199], v[32:35], v[48:51], v[196:199]
    v_mfma_f32_16x16x32_bf16 v[200:203], v[32:35], v[52:55], v[200:203]
    v_mfma_f32_16x16x32_bf16 v[204:207], v[32:35], v[56:59], v[204:207]
    v_mfma_f32_16x16x32_bf16 v[208:211], v[36:39], v[44:47], v[208:211]
    v_mfma_f32_16x16x32_bf16 v[212:215], v[36:39], v[48:51], v[212:215]
    v_mfma_f32_16x16x32_bf16 v[216:219], v[36:39], v[52:55], v[216:219]
    v_mfma_f32_16x16x32_bf16 v[220:223], v[36:39], v[56:59], v[220:223]
    v_mfma_f32_16x16x32_bf16 v[224:227], v[40:43], v[44:47], v[224:227]
    v_mfma_f32_16x16x32_bf16 v[228:231], v[40:43], v[48:51], v[228:231]
    v_mfma_f32_16x16x32_bf16 v[232:235], v[40:43], v[52:55], v[232:235]
    v_mfma_f32_16x16x32_bf16 v[236:239], v[40:43], v[56:59], v[236:239]
    s_waitcnt lgkmcnt(0)
    s_barrier
    v_mfma_f32_16x16x32_bf16 v[128:131], v[60:63], v[88:91], v[128:131]
    ds_read_b64_tr_b16 v[44:45], v117 offset:0
    v_mfma_f32_16x16x32_bf16 v[132:135], v[60:63], v[92:95], v[132:135]
    ds_read_b64_tr_b16 v[46:47], v117 offset:1024
    v_mfma_f32_16x16x32_bf16 v[136:139], v[60:63], v[96:99], v[136:139]
    ds_read_b128 v[16:19], v116 offset:0
    v_mfma_f32_16x16x32_bf16 v[140:143], v[60:63], v[100:103], v[140:143]
    ds_read_b64_tr_b16 v[48:49], v118 offset:0
    v_mfma_f32_16x16x32_bf16 v[144:147], v[64:67], v[88:91], v[144:147]
    ds_read_b64_tr_b16 v[50:51], v118 offset:1024
    v_mfma_f32_16x16x32_bf16 v[148:151], v[64:67], v[92:95], v[148:151]
    ds_read_b128 v[20:23], v116 offset:1024
    v_mfma_f32_16x16x32_bf16 v[152:155], v[64:67], v[96:99], v[152:155]
    ds_read_b64_tr_b16 v[52:53], v119 offset:0
    v_mfma_f32_16x16x32_bf16 v[156:159], v[64:67], v[100:103], v[156:159]
    ds_read_b64_tr_b16 v[54:55], v119 offset:1024
    v_mfma_f32_16x16x32_bf16 v[160:163], v[68:71], v[88:91], v[160:163]
    ds_read_b128 v[24:27], v116 offset:2048
    v_mfma_f32_16x16x32_bf16 v[164:167], v[68:71], v[92:95], v[164:167]
    ds_read_b64_tr_b16 v[56:57], v120 offset:0
    v_mfma_f32_16x16x32_bf16 v[168:171], v[68:71], v[96:99], v[168:171]
    ds_read_b64_tr_b16 v[58:59], v120 offset:1024
    v_mfma_f32_16x16x32_bf16 v[172:175], v[68:71], v[100:103], v[172:175]
    ds_read_b128 v[28:31], v116 offset:3072
    v_mfma_f32_16x16x32_bf16 v[176:179], v[72:75], v[88:91], v[176:179]
    ds_read_b128 v[32:35], v116 offset:4096
    v_mfma_f32_16x16x32_bf16 v[180:183], v[72:75], v[92:95], v[180:183]
    ds_read_b128 v[36:39], v116 offset:5120
    v_mfma_f32_16x16x32_bf16 v[184:187], v[72:75], v[96:99], v[184:187]
    ds_read_b128 v[40:43], v116 offset:6144
    v_mfma_f32_16x16x32_bf16 v[188:191], v[72:75], v[100:103], v[188:191]
    v_mfma_f32_16x16x32_bf16 v[192:195], v[76:79], v[88:91], v[192:195]
    v_mfma_f32_16x16x32_bf16 v[196:199], v[76:79], v[92:95], v[196:199]
    v_mfma_f32_16x16x32_bf16 v[200:203], v[76:79], v[96:99], v[200:203]
    v_mfma_f32_16x16x32_bf16 v[204:207], v[76:79], v[100:103], v[204:207]
    v_mfma_f32_16x16x32_bf16 v[208:211], v[80:83], v[88:91], v[208:211]
    v_mfma_f32_16x16x32_bf16 v[212:215], v[80:83], v[92:95], v[212:215]
    v_mfma_f32_16x16x32_bf16 v[216:219], v[80:83], v[96:99], v[216:219]
    v_mfma_f32_16x16x32_bf16 v[220:223], v[80:83], v[100:103], v[220:223]
    v_mfma_f32_16x16x32_bf16 v[224:227], v[84:87], v[88:91], v[224:227]
    v_mfma_f32_16x16x32_bf16 v[228:231], v[84:87], v[92:95], v[228:231]
    v_mfma_f32_16x16x32_bf16 v[232:235], v[84:87], v[96:99], v[232:235]
    v_mfma_f32_16x16x32_bf16 v[236:239], v[84:87], v[100:103], v[236:239]
    s_waitcnt lgkmcnt(0)
    v_mfma_f32_16x16x32_bf16 v[128:131], v[16:19], v[44:47], v[128:131]
    ds_read_b64_tr_b16 v[88:89], v117 offset:8192
    v_mfma_f32_16x16x32_bf16 v[132:135], v[16:19], v[48:51], v[132:135]
    ds_read_b64_tr_b16 v[90:91], v117 offset:9216
    v_mfma_f32_16x16x32_bf16 v[136:139], v[16:19], v[52:55], v[136:139]
    ds_read_b128 v[60:63], v116 offset:14336
    v_mfma_f32_16x16x32_bf16 v[140:143], v[16:19], v[56:59], v[140:143]
    ds_read_b64_tr_b16 v[92:93], v118 offset:8192
    v_mfma_f32_16x16x32_bf16 v[144:147], v[20:23], v[44:47], v[144:147]
    ds_read_b64_tr_b16 v[94:95], v118 offset:9216
    v_mfma_f32_16x16x32_bf16 v[148:151], v[20:23], v[48:51], v[148:151]
    ds_read_b128 v[64:67], v116 offset:15360
    v_mfma_f32_16x16x32_bf16 v[152:155], v[20:23], v[52:55], v[152:155]
    ds_read_b64_tr_b16 v[96:97], v119 offset:8192
    v_mfma_f32_16x16x32_bf16 v[156:159], v[20:23], v[56:59], v[156:159]
    ds_read_b64_tr_b16 v[98:99], v119 offset:9216
    v_mfma_f32_16x16x32_bf16 v[160:163], v[24:27], v[44:47], v[160:163]
    ds_read_b128 v[68:71], v116 offset:16384
    v_mfma_f32_16x16x32_bf16 v[164:167], v[24:27], v[48:51], v[164:167]
    ds_read_b64_tr_b16 v[100:101], v120 offset:8192
    v_mfma_f32_16x16x32_bf16 v[168:171], v[24:27], v[52:55], v[168:171]
    ds_read_b64_tr_b16 v[102:103], v120 offset:9216
    v_mfma_f32_16x16x32_bf16 v[172:175], v[24:27], v[56:59], v[172:175]
    ds_read_b128 v[72:75], v116 offset:17408
    v_mfma_f32_16x16x32_bf16 v[176:179], v[28:31], v[44:47], v[176:179]
    ds_read_b128 v[76:79], v116 offset:18432
    v_mfma_f32_16x16x32_bf16 v[180:183], v[28:31], v[48:51], v[180:183]
    ds_read_b128 v[80:83], v116 offset:19456
    v_mfma_f32_16x16x32_bf16 v[184:187], v[28:31], v[52:55], v[184:187]
    ds_read_b128 v[84:87], v116 offset:20480
    v_mfma_f32_16x16x32_bf16 v[188:191], v[28:31], v[56:59], v[188:191]
    v_mfma_f32_16x16x32_bf16 v[192:195], v[32:35], v[44:47], v[192:195]
    v_mfma_f32_16x16x32_bf16 v[196:199], v[32:35], v[48:51], v[196:199]
    v_mfma_f32_16x16x32_bf16 v[200:203], v[32:35], v[52:55], v[200:203]
    v_mfma_f32_16x16x32_bf16 v[204:207], v[32:35], v[56:59], v[204:207]
    v_mfma_f32_16x16x32_bf16 v[208:211], v[36:39], v[44:47], v[208:211]
    v_mfma_f32_16x16x32_bf16 v[212:215], v[36:39], v[48:51], v[212:215]
    v_mfma_f32_16x16x32_bf16 v[216:219], v[36:39], v[52:55], v[216:219]
    v_mfma_f32_16x16x32_bf16 v[220:223], v[36:39], v[56:59], v[220:223]
    v_mfma_f32_16x16x32_bf16 v[224:227], v[40:43], v[44:47], v[224:227]
    v_mfma_f32_16x16x32_bf16 v[228:231], v[40:43], v[48:51], v[228:231]
    v_mfma_f32_16x16x32_bf16 v[232:235], v[40:43], v[52:55], v[232:235]
    v_mfma_f32_16x16x32_bf16 v[236:239], v[40:43], v[56:59], v[236:239]
    s_waitcnt lgkmcnt(0)
    s_barrier
    v_mfma_f32_16x16x32_bf16 v[128:131], v[60:63], v[88:91], v[128:131]
    ds_read_b64_tr_b16 v[44:45], v122 offset:0
    v_mfma_f32_16x16x32_bf16 v[132:135], v[60:63], v[92:95], v[132:135]
    ds_read_b64_tr_b16 v[46:47], v122 offset:1024
    v_mfma_f32_16x16x32_bf16 v[136:139], v[60:63], v[96:99], v[136:139]
    ds_read_b128 v[16:19], v121 offset:0
    v_mfma_f32_16x16x32_bf16 v[140:143], v[60:63], v[100:103], v[140:143]
    ds_read_b64_tr_b16 v[48:49], v123 offset:0
    v_mfma_f32_16x16x32_bf16 v[144:147], v[64:67], v[88:91], v[144:147]
    ds_read_b64_tr_b16 v[50:51], v123 offset:1024
    v_mfma_f32_16x16x32_bf16 v[148:151], v[64:67], v[92:95], v[148:151]
    ds_read_b128 v[20:23], v121 offset:1024
    v_mfma_f32_16x16x32_bf16 v[152:155], v[64:67], v[96:99], v[152:155]
    ds_read_b64_tr_b16 v[52:53], v124 offset:0
    v_mfma_f32_16x16x32_bf16 v[156:159], v[64:67], v[100:103], v[156:159]
    ds_read_b64_tr_b16 v[54:55], v124 offset:1024
    v_mfma_f32_16x16x32_bf16 v[160:163], v[68:71], v[88:91], v[160:163]
    ds_read_b128 v[24:27], v121 offset:2048
    v_mfma_f32_16x16x32_bf16 v[164:167], v[68:71], v[92:95], v[164:167]
    ds_read_b64_tr_b16 v[56:57], v125 offset:0
    v_mfma_f32_16x16x32_bf16 v[168:171], v[68:71], v[96:99], v[168:171]
    ds_read_b64_tr_b16 v[58:59], v125 offset:1024
    v_mfma_f32_16x16x32_bf16 v[172:175], v[68:71], v[100:103], v[172:175]
    ds_read_b128 v[28:31], v121 offset:3072
    v_mfma_f32_16x16x32_bf16 v[176:179], v[72:75], v[88:91], v[176:179]
    ds_read_b128 v[32:35], v121 offset:4096
    v_mfma_f32_16x16x32_bf16 v[180:183], v[72:75], v[92:95], v[180:183]
    ds_read_b128 v[36:39], v121 offset:5120
    v_mfma_f32_16x16x32_bf16 v[184:187], v[72:75], v[96:99], v[184:187]
    ds_read_b128 v[40:43], v121 offset:6144
    v_mfma_f32_16x16x32_bf16 v[188:191], v[72:75], v[100:103], v[188:191]
    v_mfma_f32_16x16x32_bf16 v[192:195], v[76:79], v[88:91], v[192:195]
    v_mfma_f32_16x16x32_bf16 v[196:199], v[76:79], v[92:95], v[196:199]
    v_mfma_f32_16x16x32_bf16 v[200:203], v[76:79], v[96:99], v[200:203]
    v_mfma_f32_16x16x32_bf16 v[204:207], v[76:79], v[100:103], v[204:207]
    v_mfma_f32_16x16x32_bf16 v[208:211], v[80:83], v[88:91], v[208:211]
    v_mfma_f32_16x16x32_bf16 v[212:215], v[80:83], v[92:95], v[212:215]
    v_mfma_f32_16x16x32_bf16 v[216:219], v[80:83], v[96:99], v[216:219]
    v_mfma_f32_16x16x32_bf16 v[220:223], v[80:83], v[100:103], v[220:223]
    v_mfma_f32_16x16x32_bf16 v[224:227], v[84:87], v[88:91], v[224:227]
    v_mfma_f32_16x16x32_bf16 v[228:231], v[84:87], v[92:95], v[228:231]
    v_mfma_f32_16x16x32_bf16 v[232:235], v[84:87], v[96:99], v[232:235]
    v_mfma_f32_16x16x32_bf16 v[236:239], v[84:87], v[100:103], v[236:239]
    s_waitcnt lgkmcnt(0)
    v_mfma_f32_16x16x32_bf16 v[128:131], v[16:19], v[44:47], v[128:131]
    ds_read_b64_tr_b16 v[88:89], v122 offset:8192
    v_mfma_f32_16x16x32_bf16 v[132:135], v[16:19], v[48:51], v[132:135]
    ds_read_b64_tr_b16 v[90:91], v122 offset:9216
    v_mfma_f32_16x16x32_bf16 v[136:139], v[16:19], v[52:55], v[136:139]
    ds_read_b128 v[60:63], v121 offset:14336
    v_mfma_f32_16x16x32_bf16 v[140:143], v[16:19], v[56:59], v[140:143]
    ds_read_b64_tr_b16 v[92:93], v123 offset:8192
    v_mfma_f32_16x16x32_bf16 v[144:147], v[20:23], v[44:47], v[144:147]
    ds_read_b64_tr_b16 v[94:95], v123 offset:9216
    v_mfma_f32_16x16x32_bf16 v[148:151], v[20:23], v[48:51], v[148:151]
    ds_read_b128 v[64:67], v121 offset:15360
    v_mfma_f32_16x16x32_bf16 v[152:155], v[20:23], v[52:55], v[152:155]
    ds_read_b64_tr_b16 v[96:97], v124 offset:8192
    v_mfma_f32_16x16x32_bf16 v[156:159], v[20:23], v[56:59], v[156:159]
    ds_read_b64_tr_b16 v[98:99], v124 offset:9216
    v_mfma_f32_16x16x32_bf16 v[160:163], v[24:27], v[44:47], v[160:163]
    ds_read_b128 v[68:71], v121 offset:16384
    v_mfma_f32_16x16x32_bf16 v[164:167], v[24:27], v[48:51], v[164:167]
    ds_read_b64_tr_b16 v[100:101], v125 offset:8192
    v_mfma_f32_16x16x32_bf16 v[168:171], v[24:27], v[52:55], v[168:171]
    ds_read_b64_tr_b16 v[102:103], v125 offset:9216
    v_mfma_f32_16x16x32_bf16 v[172:175], v[24:27], v[56:59], v[172:175]
    ds_read_b128 v[72:75], v121 offset:17408
    v_mfma_f32_16x16x32_bf16 v[176:179], v[28:31], v[44:47], v[176:179]
    ds_read_b128 v[76:79], v121 offset:18432
    v_mfma_f32_16x16x32_bf16 v[180:183], v[28:31], v[48:51], v[180:183]
    ds_read_b128 v[80:83], v121 offset:19456
    v_mfma_f32_16x16x32_bf16 v[184:187], v[28:31], v[52:55], v[184:187]
    ds_read_b128 v[84:87], v121 offset:20480
    v_mfma_f32_16x16x32_bf16 v[188:191], v[28:31], v[56:59], v[188:191]
    v_mfma_f32_16x16x32_bf16 v[192:195], v[32:35], v[44:47], v[192:195]
    v_mfma_f32_16x16x32_bf16 v[196:199], v[32:35], v[48:51], v[196:199]
    v_mfma_f32_16x16x32_bf16 v[200:203], v[32:35], v[52:55], v[200:203]
    v_mfma_f32_16x16x32_bf16 v[204:207], v[32:35], v[56:59], v[204:207]
    v_mfma_f32_16x16x32_bf16 v[208:211], v[36:39], v[44:47], v[208:211]
    v_mfma_f32_16x16x32_bf16 v[212:215], v[36:39], v[48:51], v[212:215]
    v_mfma_f32_16x16x32_bf16 v[216:219], v[36:39], v[52:55], v[216:219]
    v_mfma_f32_16x16x32_bf16 v[220:223], v[36:39], v[56:59], v[220:223]
    v_mfma_f32_16x16x32_bf16 v[224:227], v[40:43], v[44:47], v[224:227]
    v_mfma_f32_16x16x32_bf16 v[228:231], v[40:43], v[48:51], v[228:231]
    v_mfma_f32_16x16x32_bf16 v[232:235], v[40:43], v[52:55], v[232:235]
    v_mfma_f32_16x16x32_bf16 v[236:239], v[40:43], v[56:59], v[236:239]
    s_waitcnt lgkmcnt(0)
    v_mov_b32 v126, 160000
    s_barrier
    v_mfma_f32_16x16x32_bf16 v[128:131], v[60:63], v[88:91], v[128:131]
    ds_read_b64_tr_b16 v[44:45], v6 offset:0
    v_mfma_f32_16x16x32_bf16 v[132:135], v[60:63], v[92:95], v[132:135]
    ds_read_b64_tr_b16 v[46:47], v6 offset:1024
    v_mfma_f32_16x16x32_bf16 v[136:139], v[60:63], v[96:99], v[136:139]
    ds_read_b128 v[16:19], v5 offset:0
    v_mfma_f32_16x16x32_bf16 v[140:143], v[60:63], v[100:103], v[140:143]
    ds_read_b64_tr_b16 v[48:49], v7 offset:0
    v_mfma_f32_16x16x32_bf16 v[144:147], v[64:67], v[88:91], v[144:147]
    ds_read_b64_tr_b16 v[50:51], v7 offset:1024
    v_mfma_f32_16x16x32_bf16 v[148:151], v[64:67], v[92:95], v[148:151]
    ds_read_b128 v[20:23], v5 offset:1024
    v_mfma_f32_16x16x32_bf16 v[152:155], v[64:67], v[96:99], v[152:155]
    ds_read_b64_tr_b16 v[52:53], v8 offset:0
    v_mfma_f32_16x16x32_bf16 v[156:159], v[64:67], v[100:103], v[156:159]
    ds_read_b64_tr_b16 v[54:55], v8 offset:1024
    v_mfma_f32_16x16x32_bf16 v[160:163], v[68:71], v[88:91], v[160:163]
    ds_read_b128 v[24:27], v5 offset:2048
    v_mfma_f32_16x16x32_bf16 v[164:167], v[68:71], v[92:95], v[164:167]
    ds_read_b64_tr_b16 v[56:57], v9 offset:0
    v_mfma_f32_16x16x32_bf16 v[168:171], v[68:71], v[96:99], v[168:171]
    ds_read_b64_tr_b16 v[58:59], v9 offset:1024
    v_mfma_f32_16x16x32_bf16 v[172:175], v[68:71], v[100:103], v[172:175]
    ds_read_b128 v[28:31], v5 offset:3072
    v_mfma_f32_16x16x32_bf16 v[176:179], v[72:75], v[88:91], v[176:179]
    ds_read_b128 v[32:35], v5 offset:4096
    v_mfma_f32_16x16x32_bf16 v[180:183], v[72:75], v[92:95], v[180:183]
    ds_read_b128 v[36:39], v5 offset:5120
    v_mfma_f32_16x16x32_bf16 v[184:187], v[72:75], v[96:99], v[184:187]
    ds_read_b128 v[40:43], v5 offset:6144
    v_mfma_f32_16x16x32_bf16 v[188:191], v[72:75], v[100:103], v[188:191]
    v_mfma_f32_16x16x32_bf16 v[192:195], v[76:79], v[88:91], v[192:195]
    v_mfma_f32_16x16x32_bf16 v[196:199], v[76:79], v[92:95], v[196:199]
    v_mfma_f32_16x16x32_bf16 v[200:203], v[76:79], v[96:99], v[200:203]
    v_mfma_f32_16x16x32_bf16 v[204:207], v[76:79], v[100:103], v[204:207]
    v_mfma_f32_16x16x32_bf16 v[208:211], v[80:83], v[88:91], v[208:211]
    v_mfma_f32_16x16x32_bf16 v[212:215], v[80:83], v[92:95], v[212:215]
    v_mfma_f32_16x16x32_bf16 v[216:219], v[80:83], v[96:99], v[216:219]
    v_mfma_f32_16x16x32_bf16 v[220:223], v[80:83], v[100:103], v[220:223]
    v_mfma_f32_16x16x32_bf16 v[224:227], v[84:87], v[88:91], v[224:227]
    v_mfma_f32_16x16x32_bf16 v[228:231], v[84:87], v[92:95], v[228:231]
    v_mfma_f32_16x16x32_bf16 v[232:235], v[84:87], v[96:99], v[232:235]
    v_mfma_f32_16x16x32_bf16 v[236:239], v[84:87], v[100:103], v[236:239]
    s_waitcnt lgkmcnt(0)
    v_mfma_f32_16x16x32_bf16 v[128:131], v[16:19], v[44:47], v[128:131]
    ds_read_b64_tr_b16 v[88:89], v6 offset:8192
    v_mfma_f32_16x16x32_bf16 v[132:135], v[16:19], v[48:51], v[132:135]
    ds_read_b64_tr_b16 v[90:91], v6 offset:9216
    v_mfma_f32_16x16x32_bf16 v[136:139], v[16:19], v[52:55], v[136:139]
    ds_read_b128 v[60:63], v5 offset:14336
    v_mfma_f32_16x16x32_bf16 v[140:143], v[16:19], v[56:59], v[140:143]
    ds_read_b64_tr_b16 v[92:93], v7 offset:8192
    v_mfma_f32_16x16x32_bf16 v[144:147], v[20:23], v[44:47], v[144:147]
    ds_read_b64_tr_b16 v[94:95], v7 offset:9216
    v_mfma_f32_16x16x32_bf16 v[148:151], v[20:23], v[48:51], v[148:151]
    ds_read_b128 v[64:67], v5 offset:15360
    v_mfma_f32_16x16x32_bf16 v[152:155], v[20:23], v[52:55], v[152:155]
    ds_read_b64_tr_b16 v[96:97], v8 offset:8192
    v_mfma_f32_16x16x32_bf16 v[156:159], v[20:23], v[56:59], v[156:159]
    ds_read_b64_tr_b16 v[98:99], v8 offset:9216
    v_mfma_f32_16x16x32_bf16 v[160:163], v[24:27], v[44:47], v[160:163]
    ds_read_b128 v[68:71], v5 offset:16384
    v_mfma_f32_16x16x32_bf16 v[164:167], v[24:27], v[48:51], v[164:167]
    ds_read_b64_tr_b16 v[100:101], v9 offset:8192
    v_mfma_f32_16x16x32_bf16 v[168:171], v[24:27], v[52:55], v[168:171]
    ds_read_b64_tr_b16 v[102:103], v9 offset:9216
    v_mfma_f32_16x16x32_bf16 v[172:175], v[24:27], v[56:59], v[172:175]
    ds_read_b128 v[72:75], v5 offset:17408
    v_mfma_f32_16x16x32_bf16 v[176:179], v[28:31], v[44:47], v[176:179]
    ds_read_b128 v[76:79], v5 offset:18432
    v_mfma_f32_16x16x32_bf16 v[180:183], v[28:31], v[48:51], v[180:183]
    ds_read_b128 v[80:83], v5 offset:19456
    v_mfma_f32_16x16x32_bf16 v[184:187], v[28:31], v[52:55], v[184:187]
    ds_read_b128 v[84:87], v5 offset:20480
    v_mfma_f32_16x16x32_bf16 v[188:191], v[28:31], v[56:59], v[188:191]
    ds_read_b32 v127, v126 offset:32
    v_mfma_f32_16x16x32_bf16 v[192:195], v[32:35], v[44:47], v[192:195]
    v_mfma_f32_16x16x32_bf16 v[196:199], v[32:35], v[48:51], v[196:199]
    v_mfma_f32_16x16x32_bf16 v[200:203], v[32:35], v[52:55], v[200:203]
    v_mfma_f32_16x16x32_bf16 v[204:207], v[32:35], v[56:59], v[204:207]
    v_mfma_f32_16x16x32_bf16 v[208:211], v[36:39], v[44:47], v[208:211]
    v_mfma_f32_16x16x32_bf16 v[212:215], v[36:39], v[48:51], v[212:215]
    v_mfma_f32_16x16x32_bf16 v[216:219], v[36:39], v[52:55], v[216:219]
    v_mfma_f32_16x16x32_bf16 v[220:223], v[36:39], v[56:59], v[220:223]
    v_mfma_f32_16x16x32_bf16 v[224:227], v[40:43], v[44:47], v[224:227]
    v_mfma_f32_16x16x32_bf16 v[228:231], v[40:43], v[48:51], v[228:231]
    v_mfma_f32_16x16x32_bf16 v[232:235], v[40:43], v[52:55], v[232:235]
    v_mfma_f32_16x16x32_bf16 v[236:239], v[40:43], v[56:59], v[236:239]
    s_waitcnt lgkmcnt(0)
L_g_a7:
    v_readfirstlane_b32 s27, v127
    s_nop 1
    s_cmp_ge_u32 s27, 4
    s_cbranch_scc1 L_g_a7ok
    ds_read_b32 v127, v126 offset:32
    s_waitcnt lgkmcnt(0)
    s_branch L_g_a7
L_g_a7ok:
    v_mov_b32 v126, 160000
    v_mov_b32 v127, 1
    s_mov_b64 exec, 1
    ds_add_u32 v126, v127 offset:20
    s_mov_b64 exec, -1
    v_mfma_f32_16x16x32_bf16 v[128:131], v[60:63], v[88:91], v[128:131]
    ds_read_b64_tr_b16 v[44:45], v122 offset:16384
    v_mfma_f32_16x16x32_bf16 v[132:135], v[60:63], v[92:95], v[132:135]
    ds_read_b64_tr_b16 v[46:47], v122 offset:17408
    v_mfma_f32_16x16x32_bf16 v[136:139], v[60:63], v[96:99], v[136:139]
    ds_read_b128 v[16:19], v116 offset:0
    v_mfma_f32_16x16x32_bf16 v[140:143], v[60:63], v[100:103], v[140:143]
    ds_read_b64_tr_b16 v[48:49], v123 offset:16384
    v_mfma_f32_16x16x32_bf16 v[144:147], v[64:67], v[88:91], v[144:147]
    ds_read_b64_tr_b16 v[50:51], v123 offset:17408
    v_mfma_f32_16x16x32_bf16 v[148:151], v[64:67], v[92:95], v[148:151]
    ds_read_b128 v[20:23], v116 offset:1024
    v_mfma_f32_16x16x32_bf16 v[152:155], v[64:67], v[96:99], v[152:155]
    ds_read_b64_tr_b16 v[52:53], v124 offset:16384
    v_mfma_f32_16x16x32_bf16 v[156:159], v[64:67], v[100:103], v[156:159]
    ds_read_b64_tr_b16 v[54:55], v124 offset:17408
    v_mfma_f32_16x16x32_bf16 v[160:163], v[68:71], v[88:91], v[160:163]
    ds_read_b128 v[24:27], v116 offset:2048
    v_mfma_f32_16x16x32_bf16 v[164:167], v[68:71], v[92:95], v[164:167]
    ds_read_b64_tr_b16 v[56:57], v125 offset:16384
    v_mfma_f32_16x16x32_bf16 v[168:171], v[68:71], v[96:99], v[168:171]
    ds_read_b64_tr_b16 v[58:59], v125 offset:17408
    v_mfma_f32_16x16x32_bf16 v[172:175], v[68:71], v[100:103], v[172:175]
    ds_read_b128 v[28:31], v116 offset:3072
    v_mfma_f32_16x16x32_bf16 v[176:179], v[72:75], v[88:91], v[176:179]
    ds_read_b128 v[32:35], v116 offset:4096
    v_mfma_f32_16x16x32_bf16 v[180:183], v[72:75], v[92:95], v[180:183]
    ds_read_b128 v[36:39], v116 offset:5120
    v_mfma_f32_16x16x32_bf16 v[184:187], v[72:75], v[96:99], v[184:187]
    ds_read_b128 v[40:43], v116 offset:6144
    v_mfma_f32_16x16x32_bf16 v[188:191], v[72:75], v[100:103], v[188:191]
    v_mfma_f32_16x16x32_bf16 v[192:195], v[76:79], v[88:91], v[192:195]
    v_mfma_f32_16x16x32_bf16 v[196:199], v[76:79], v[92:95], v[196:199]
    v_mfma_f32_16x16x32_bf16 v[200:203], v[76:79], v[96:99], v[200:203]
    v_mfma_f32_16x16x32_bf16 v[204:207], v[76:79], v[100:103], v[204:207]
    v_mfma_f32_16x16x32_bf16 v[208:211], v[80:83], v[88:91], v[208:211]
    v_mfma_f32_16x16x32_bf16 v[212:215], v[80:83], v[92:95], v[212:215]
    v_mfma_f32_16x16x32_bf16 v[216:219], v[80:83], v[96:99], v[216:219]
    v_mfma_f32_16x16x32_bf16 v[220:223], v[80:83], v[100:103], v[220:223]
    v_mfma_f32_16x16x32_bf16 v[224:227], v[84:87], v[88:91], v[224:227]
    v_mfma_f32_16x16x32_bf16 v[228:231], v[84:87], v[92:95], v[228:231]
    v_mfma_f32_16x16x32_bf16 v[232:235], v[84:87], v[96:99], v[232:235]
    v_mfma_f32_16x16x32_bf16 v[236:239], v[84:87], v[100:103], v[236:239]
    s_waitcnt lgkmcnt(0)
    v_mfma_f32_16x16x32_bf16 v[128:131], v[16:19], v[44:47], v[128:131]
    ds_read_b64_tr_b16 v[88:89], v122 offset:24576
    v_mfma_f32_16x16x32_bf16 v[132:135], v[16:19], v[48:51], v[132:135]
    ds_read_b64_tr_b16 v[90:91], v122 offset:25600
    v_mfma_f32_16x16x32_bf16 v[136:139], v[16:19], v[52:55], v[136:139]
    ds_read_b128 v[60:63], v116 offset:14336
    v_mfma_f32_16x16x32_bf16 v[140:143], v[16:19], v[56:59], v[140:143]
    ds_read_b64_tr_b16 v[92:93], v123 offset:24576
    v_mfma_f32_16x16x32_bf16 v[144:147], v[20:23], v[44:47], v[144:147]
    ds_read_b64_tr_b16 v[94:95], v123 offset:25600
    v_mfma_f32_16x16x32_bf16 v[148:151], v[20:23], v[48:51], v[148:151]
    ds_read_b128 v[64:67], v116 offset:15360
    v_mfma_f32_16x16x32_bf16 v[152:155], v[20:23], v[52:55], v[152:155]
    ds_read_b64_tr_b16 v[96:97], v124 offset:24576
    v_mfma_f32_16x16x32_bf16 v[156:159], v[20:23], v[56:59], v[156:159]
    ds_read_b64_tr_b16 v[98:99], v124 offset:25600
    v_mfma_f32_16x16x32_bf16 v[160:163], v[24:27], v[44:47], v[160:163]
    ds_read_b128 v[68:71], v116 offset:16384
    v_mfma_f32_16x16x32_bf16 v[164:167], v[24:27], v[48:51], v[164:167]
    ds_read_b64_tr_b16 v[100:101], v125 offset:24576
    v_mfma_f32_16x16x32_bf16 v[168:171], v[24:27], v[52:55], v[168:171]
    ds_read_b64_tr_b16 v[102:103], v125 offset:25600
    v_mfma_f32_16x16x32_bf16 v[172:175], v[24:27], v[56:59], v[172:175]
    ds_read_b128 v[72:75], v116 offset:17408
    v_mfma_f32_16x16x32_bf16 v[176:179], v[28:31], v[44:47], v[176:179]
    ds_read_b128 v[76:79], v116 offset:18432
    v_mfma_f32_16x16x32_bf16 v[180:183], v[28:31], v[48:51], v[180:183]
    ds_read_b128 v[80:83], v116 offset:19456
    v_mfma_f32_16x16x32_bf16 v[184:187], v[28:31], v[52:55], v[184:187]
    ds_read_b128 v[84:87], v116 offset:20480
    v_mfma_f32_16x16x32_bf16 v[188:191], v[28:31], v[56:59], v[188:191]
    v_mfma_f32_16x16x32_bf16 v[192:195], v[32:35], v[44:47], v[192:195]
    v_mfma_f32_16x16x32_bf16 v[196:199], v[32:35], v[48:51], v[196:199]
    v_mfma_f32_16x16x32_bf16 v[200:203], v[32:35], v[52:55], v[200:203]
    v_mfma_f32_16x16x32_bf16 v[204:207], v[32:35], v[56:59], v[204:207]
    v_mfma_f32_16x16x32_bf16 v[208:211], v[36:39], v[44:47], v[208:211]
    v_mfma_f32_16x16x32_bf16 v[212:215], v[36:39], v[48:51], v[212:215]
    v_mfma_f32_16x16x32_bf16 v[216:219], v[36:39], v[52:55], v[216:219]
    v_mfma_f32_16x16x32_bf16 v[220:223], v[36:39], v[56:59], v[220:223]
    v_mfma_f32_16x16x32_bf16 v[224:227], v[40:43], v[44:47], v[224:227]
    v_mfma_f32_16x16x32_bf16 v[228:231], v[40:43], v[48:51], v[228:231]
    v_mfma_f32_16x16x32_bf16 v[232:235], v[40:43], v[52:55], v[232:235]
    v_mfma_f32_16x16x32_bf16 v[236:239], v[40:43], v[56:59], v[236:239]
    s_waitcnt lgkmcnt(0)
    v_mov_b32 v126, 160000
    v_mov_b32 v127, 1
    s_mov_b64 exec, 1
    ds_add_u32 v126, v127 offset:28
    s_mov_b64 exec, -1
    v_mfma_f32_16x16x32_bf16 v[128:131], v[60:63], v[88:91], v[128:131]
    v_mfma_f32_16x16x32_bf16 v[132:135], v[60:63], v[92:95], v[132:135]
    v_mfma_f32_16x16x32_bf16 v[136:139], v[60:63], v[96:99], v[136:139]
    v_mfma_f32_16x16x32_bf16 v[140:143], v[60:63], v[100:103], v[140:143]
    v_mfma_f32_16x16x32_bf16 v[144:147], v[64:67], v[88:91], v[144:147]
    v_mfma_f32_16x16x32_bf16 v[148:151], v[64:67], v[92:95], v[148:151]
    v_mfma_f32_16x16x32_bf16 v[152:155], v[64:67], v[96:99], v[152:155]
    v_mfma_f32_16x16x32_bf16 v[156:159], v[64:67], v[100:103], v[156:159]
    v_mfma_f32_16x16x32_bf16 v[160:163], v[68:71], v[88:91], v[160:163]
    v_mfma_f32_16x16x32_bf16 v[164:167], v[68:71], v[92:95], v[164:167]
    v_mfma_f32_16x16x32_bf16 v[168:171], v[68:71], v[96:99], v[168:171]
    v_mfma_f32_16x16x32_bf16 v[172:175], v[68:71], v[100:103], v[172:175]
    v_mfma_f32_16x16x32_bf16 v[176:179], v[72:75], v[88:91], v[176:179]
    v_mfma_f32_16x16x32_bf16 v[180:183], v[72:75], v[92:95], v[180:183]
    v_mfma_f32_16x16x32_bf16 v[184:187], v[72:75], v[96:99], v[184:187]
    v_mfma_f32_16x16x32_bf16 v[188:191], v[72:75], v[100:103], v[188:191]
    v_mfma_f32_16x16x32_bf16 v[192:195], v[76:79], v[88:91], v[192:195]
    v_mfma_f32_16x16x32_bf16 v[196:199], v[76:79], v[92:95], v[196:199]
    v_mfma_f32_16x16x32_bf16 v[200:203], v[76:79], v[96:99], v[200:203]
    v_mfma_f32_16x16x32_bf16 v[204:207], v[76:79], v[100:103], v[204:207]
    v_mfma_f32_16x16x32_bf16 v[208:211], v[80:83], v[88:91], v[208:211]
    v_mfma_f32_16x16x32_bf16 v[212:215], v[80:83], v[92:95], v[212:215]
    v_mfma_f32_16x16x32_bf16 v[216:219], v[80:83], v[96:99], v[216:219]
    v_mfma_f32_16x16x32_bf16 v[220:223], v[80:83], v[100:103], v[220:223]
    v_mfma_f32_16x16x32_bf16 v[224:227], v[84:87], v[88:91], v[224:227]
    v_mfma_f32_16x16x32_bf16 v[228:231], v[84:87], v[92:95], v[228:231]
    v_mfma_f32_16x16x32_bf16 v[232:235], v[84:87], v[96:99], v[232:235]
    v_mfma_f32_16x16x32_bf16 v[236:239], v[84:87], v[100:103], v[236:239]
L_g_rdy:
    ds_read_b32 v127, v126 offset:24
    s_waitcnt lgkmcnt(0)
    v_readfirstlane_b32 s27, v127
    s_nop 1
    s_cmp_lt_u32 s27, 4
    s_cbranch_scc1 L_g_rdy
    ds_read_b64 v[16:17], v10 offset:0
    ds_read_b64 v[18:19], v10 offset:128
    ds_read_b64 v[20:21], v13 offset:0
    ds_read_b64 v[22:23], v13 offset:128
    ds_read_b128 v[32:35], v11 offset:0
    ds_read_b128 v[36:39], v11 offset:64
    ds_read_b128 v[40:43], v11 offset:128
    ds_read_b128 v[44:47], v11 offset:192
    ds_read_b128 v[48:51], v11 offset:256
    ds_read_b128 v[52:55], v11 offset:320
    ds_read_b128 v[56:59], v11 offset:384
    ds_read_b128 v[60:63], v11 offset:448
    ds_read_b128 v[64:67], v11 offset:512
    ds_read_b128 v[68:71], v11 offset:576
    ds_read_b128 v[72:75], v11 offset:640
    ds_read_b128 v[76:79], v11 offset:704
    ds_read_b128 v[80:83], v11 offset:768
    ds_read_b128 v[84:87], v11 offset:832
    s_mov_b32 s27, 3216550459
    s_waitcnt lgkmcnt(14)
    v_mul_f32 v24, s27, v17
    v_mul_f32 v26, s27, v19
    v_mul_f32 v28, s27, v21
    v_mul_f32 v30, s27, v23
    s_lshl_b32 s21, s16, 11
    s_lshl_b32 s22, s17, 7
    s_add_u32 s21, s21, s22
    s_add_u32 s21, s21, 24215552
    s_add_u32 s23, s21, 163840
    v_mov_b32 v5, 160000
    v_mov_b32 v8, s60
    s_waitcnt lgkmcnt(6)
    v_pk_fma_f32 v[88:89], v[16:17], v[32:33], v[128:129] op_sel_hi:[0,1,1]
    v_pk_fma_f32 v[90:91], v[16:17], v[34:35], v[130:131] op_sel_hi:[0,1,1]
    v_pk_fma_f32 v[92:93], v[16:17], v[40:41], v[144:145] op_sel_hi:[0,1,1]
    v_pk_fma_f32 v[94:95], v[16:17], v[42:43], v[146:147] op_sel_hi:[0,1,1]
    v_pk_fma_f32 v[96:97], v[16:17], v[48:49], v[160:161] op_sel_hi:[0,1,1]
    v_pk_fma_f32 v[98:99], v[16:17], v[50:51], v[162:163] op_sel_hi:[0,1,1]
    v_pk_fma_f32 v[100:101], v[16:17], v[56:57], v[176:177] op_sel_hi:[0,1,1]
    v_pk_fma_f32 v[102:103], v[16:17], v[58:59], v[178:179] op_sel_hi:[0,1,1]
    v_pk_fma_f32 v[88:89], v[24:25], v[88:89], v[36:37] op_sel_hi:[0,1,1]
    v_pk_fma_f32 v[90:91], v[16:17], v[90:91], v[38:39] op_sel:[1,0,0] op_sel_hi:[1,1,1]
    v_pk_fma_f32 v[92:93], v[24:25], v[92:93], v[44:45] op_sel_hi:[0,1,1]
    v_pk_fma_f32 v[94:95], v[16:17], v[94:95], v[46:47] op_sel:[1,0,0] op_sel_hi:[1,1,1]
    v_pk_fma_f32 v[96:97], v[24:25], v[96:97], v[52:53] op_sel_hi:[0,1,1]
    v_pk_fma_f32 v[98:99], v[16:17], v[98:99], v[54:55] op_sel:[1,0,0] op_sel_hi:[1,1,1]
    v_pk_fma_f32 v[100:101], v[24:25], v[100:101], v[60:61] op_sel_hi:[0,1,1]
    v_pk_fma_f32 v[102:103], v[16:17], v[102:103], v[62:63] op_sel:[1,0,0] op_sel_hi:[1,1,1]
    v_exp_f32 v88, v88
    v_exp_f32 v89, v89
    v_exp_f32 v92, v92
    v_exp_f32 v93, v93
    v_exp_f32 v96, v96
    v_exp_f32 v97, v97
    v_exp_f32 v100, v100
    v_exp_f32 v101, v101
    v_pk_add_f32 v[88:89], v[88:89], 1.0 op_sel_hi:[1,0]
    v_pk_add_f32 v[92:93], v[92:93], 1.0 op_sel_hi:[1,0]
    v_pk_add_f32 v[96:97], v[96:97], 1.0 op_sel_hi:[1,0]
    v_pk_add_f32 v[100:101], v[100:101], 1.0 op_sel_hi:[1,0]
    v_rcp_f32 v88, v88
    v_rcp_f32 v89, v89
    v_rcp_f32 v92, v92
    v_rcp_f32 v93, v93
    v_rcp_f32 v96, v96
    v_rcp_f32 v97, v97
    v_rcp_f32 v100, v100
    v_rcp_f32 v101, v101
    v_pk_mul_f32 v[88:89], v[88:89], v[90:91]
    v_pk_mul_f32 v[92:93], v[92:93], v[94:95]
    v_pk_mul_f32 v[96:97], v[96:97], v[98:99]
    v_pk_mul_f32 v[100:101], v[100:101], v[102:103]
    v_cvt_pk_bf16_f32 v116, v88, v89
    v_cvt_pk_bf16_f32 v117, v92, v93
    v_cvt_pk_bf16_f32 v118, v96, v97
    v_cvt_pk_bf16_f32 v119, v100, v101
    buffer_store_dwordx4 v[116:119], v12, s[8:11], s32 offen sc1
    s_waitcnt lgkmcnt(0)
    v_pk_fma_f32 v[88:89], v[16:17], v[64:65], v[192:193] op_sel_hi:[0,1,1]
    v_pk_fma_f32 v[90:91], v[16:17], v[66:67], v[194:195] op_sel_hi:[0,1,1]
    v_pk_fma_f32 v[92:93], v[16:17], v[72:73], v[208:209] op_sel_hi:[0,1,1]
    v_pk_fma_f32 v[94:95], v[16:17], v[74:75], v[210:211] op_sel_hi:[0,1,1]
    v_pk_fma_f32 v[96:97], v[16:17], v[80:81], v[224:225] op_sel_hi:[0,1,1]
    v_pk_fma_f32 v[98:99], v[16:17], v[82:83], v[226:227] op_sel_hi:[0,1,1]
    v_pk_fma_f32 v[88:89], v[24:25], v[88:89], v[68:69] op_sel_hi:[0,1,1]
    v_pk_fma_f32 v[90:91], v[16:17], v[90:91], v[70:71] op_sel:[1,0,0] op_sel_hi:[1,1,1]
    v_pk_fma_f32 v[92:93], v[24:25], v[92:93], v[76:77] op_sel_hi:[0,1,1]
    v_pk_fma_f32 v[94:95], v[16:17], v[94:95], v[78:79] op_sel:[1,0,0] op_sel_hi:[1,1,1]
    v_pk_fma_f32 v[96:97], v[24:25], v[96:97], v[84:85] op_sel_hi:[0,1,1]
    v_pk_fma_f32 v[98:99], v[16:17], v[98:99], v[86:87] op_sel:[1,0,0] op_sel_hi:[1,1,1]
    v_exp_f32 v88, v88
    v_exp_f32 v89, v89
    v_exp_f32 v92, v92
    v_exp_f32 v93, v93
    v_exp_f32 v96, v96
    v_exp_f32 v97, v97
    v_pk_add_f32 v[88:89], v[88:89], 1.0 op_sel_hi:[1,0]
    v_pk_add_f32 v[92:93], v[92:93], 1.0 op_sel_hi:[1,0]
    v_pk_add_f32 v[96:97], v[96:97], 1.0 op_sel_hi:[1,0]
    v_rcp_f32 v88, v88
    v_rcp_f32 v89, v89
    v_rcp_f32 v92, v92
    v_rcp_f32 v93, v93
    v_rcp_f32 v96, v96
    v_rcp_f32 v97, v97
    v_pk_mul_f32 v[88:89], v[88:89], v[90:91]
    v_pk_mul_f32 v[92:93], v[92:93], v[94:95]
    v_pk_mul_f32 v[96:97], v[96:97], v[98:99]
    v_cvt_pk_bf16_f32 v120, v88, v89
    v_cvt_pk_bf16_f32 v121, v92, v93
    v_cvt_pk_bf16_f32 v122, v96, v97
    buffer_store_dwordx3 v[120:122], v15, s[8:11], s32 offen offset:1024 sc1
    v_pk_fma_f32 v[88:89], v[18:19], v[32:33], v[132:133] op_sel_hi:[0,1,1]
    v_pk_fma_f32 v[90:91], v[18:19], v[34:35], v[134:135] op_sel_hi:[0,1,1]
    v_pk_fma_f32 v[92:93], v[18:19], v[40:41], v[148:149] op_sel_hi:[0,1,1]
    v_pk_fma_f32 v[94:95], v[18:19], v[42:43], v[150:151] op_sel_hi:[0,1,1]
    v_pk_fma_f32 v[96:97], v[18:19], v[48:49], v[164:165] op_sel_hi:[0,1,1]
    v_pk_fma_f32 v[98:99], v[18:19], v[50:51], v[166:167] op_sel_hi:[0,1,1]
    v_pk_fma_f32 v[100:101], v[18:19], v[56:57], v[180:181] op_sel_hi:[0,1,1]
    v_pk_fma_f32 v[102:103], v[18:19], v[58:59], v[182:183] op_sel_hi:[0,1,1]
    v_pk_fma_f32 v[88:89], v[26:27], v[88:89], v[36:37] op_sel_hi:[0,1,1]
    v_pk_fma_f32 v[90:91], v[18:19], v[90:91], v[38:39] op_sel:[1,0,0] op_sel_hi:[1,1,1]
    v_pk_fma_f32 v[92:93], v[26:27], v[92:93], v[44:45] op_sel_hi:[0,1,1]
    v_pk_fma_f32 v[94:95], v[18:19], v[94:95], v[46:47] op_sel:[1,0,0] op_sel_hi:[1,1,1]
    v_pk_fma_f32 v[96:97], v[26:27], v[96:97], v[52:53] op_sel_hi:[0,1,1]
    v_pk_fma_f32 v[98:99], v[18:19], v[98:99], v[54:55] op_sel:[1,0,0] op_sel_hi:[1,1,1]
    v_pk_fma_f32 v[100:101], v[26:27], v[100:101], v[60:61] op_sel_hi:[0,1,1]
    v_pk_fma_f32 v[102:103], v[18:19], v[102:103], v[62:63] op_sel:[1,0,0] op_sel_hi:[1,1,1]
    v_exp_f32 v88, v88
    v_exp_f32 v89, v89
    v_exp_f32 v92, v92
    v_exp_f32 v93, v93
    v_exp_f32 v96, v96
    v_exp_f32 v97, v97
    v_exp_f32 v100, v100
    v_exp_f32 v101, v101
    v_pk_add_f32 v[88:89], v[88:89], 1.0 op_sel_hi:[1,0]
    v_pk_add_f32 v[92:93], v[92:93], 1.0 op_sel_hi:[1,0]
    v_pk_add_f32 v[96:97], v[96:97], 1.0 op_sel_hi:[1,0]
    v_pk_add_f32 v[100:101], v[100:101], 1.0 op_sel_hi:[1,0]
    v_rcp_f32 v88, v88
    v_rcp_f32 v89, v89
    v_rcp_f32 v92, v92
    v_rcp_f32 v93, v93
    v_rcp_f32 v96, v96
    v_rcp_f32 v97, v97
    v_rcp_f32 v100, v100
    v_rcp_f32 v101, v101
    v_pk_mul_f32 v[88:89], v[88:89], v[90:91]
    v_pk_mul_f32 v[92:93], v[92:93], v[94:95]
    v_pk_mul_f32 v[96:97], v[96:97], v[98:99]
    v_pk_mul_f32 v[100:101], v[100:101], v[102:103]
    v_cvt_pk_bf16_f32 v104, v88, v89
    v_cvt_pk_bf16_f32 v105, v92, v93
    v_cvt_pk_bf16_f32 v106, v96, v97
    v_cvt_pk_bf16_f32 v107, v100, v101
    buffer_store_dwordx4 v[104:107], v12, s[8:11], s33 offen sc1
    v_pk_fma_f32 v[88:89], v[18:19], v[64:65], v[196:197] op_sel_hi:[0,1,1]
    v_pk_fma_f32 v[90:91], v[18:19], v[66:67], v[198:199] op_sel_hi:[0,1,1]
    v_pk_fma_f32 v[92:93], v[18:19], v[72:73], v[212:213] op_sel_hi:[0,1,1]
    v_pk_fma_f32 v[94:95], v[18:19], v[74:75], v[214:215] op_sel_hi:[0,1,1]
    v_pk_fma_f32 v[96:97], v[18:19], v[80:81], v[228:229] op_sel_hi:[0,1,1]
    v_pk_fma_f32 v[98:99], v[18:19], v[82:83], v[230:231] op_sel_hi:[0,1,1]
    v_pk_fma_f32 v[88:89], v[26:27], v[88:89], v[68:69] op_sel_hi:[0,1,1]
    v_pk_fma_f32 v[90:91], v[18:19], v[90:91], v[70:71] op_sel:[1,0,0] op_sel_hi:[1,1,1]
    v_pk_fma_f32 v[92:93], v[26:27], v[92:93], v[76:77] op_sel_hi:[0,1,1]
    v_pk_fma_f32 v[94:95], v[18:19], v[94:95], v[78:79] op_sel:[1,0,0] op_sel_hi:[1,1,1]
    v_pk_fma_f32 v[96:97], v[26:27], v[96:97], v[84:85] op_sel_hi:[0,1,1]
    v_pk_fma_f32 v[98:99], v[18:19], v[98:99], v[86:87] op_sel:[1,0,0] op_sel_hi:[1,1,1]
    v_exp_f32 v88, v88
    v_exp_f32 v89, v89
    v_exp_f32 v92, v92
    v_exp_f32 v93, v93
    v_exp_f32 v96, v96
    v_exp_f32 v97, v97
    v_pk_add_f32 v[88:89], v[88:89], 1.0 op_sel_hi:[1,0]
    v_pk_add_f32 v[92:93], v[92:93], 1.0 op_sel_hi:[1,0]
    v_pk_add_f32 v[96:97], v[96:97], 1.0 op_sel_hi:[1,0]
    v_rcp_f32 v88, v88
    v_rcp_f32 v89, v89
    v_rcp_f32 v92, v92
    v_rcp_f32 v93, v93
    v_rcp_f32 v96, v96
    v_rcp_f32 v97, v97
    v_pk_mul_f32 v[88:89], v[88:89], v[90:91]
    v_pk_mul_f32 v[92:93], v[92:93], v[94:95]
    v_pk_mul_f32 v[96:97], v[96:97], v[98:99]
    v_cvt_pk_bf16_f32 v108, v88, v89
    v_cvt_pk_bf16_f32 v109, v92, v93
    v_cvt_pk_bf16_f32 v110, v96, v97
    buffer_store_dwordx3 v[108:110], v15, s[8:11], s33 offen offset:1024 sc1
    v_pk_fma_f32 v[88:89], v[20:21], v[32:33], v[136:137] op_sel_hi:[0,1,1]
    v_pk_fma_f32 v[90:91], v[20:21], v[34:35], v[138:139] op_sel_hi:[0,1,1]
    v_pk_fma_f32 v[92:93], v[20:21], v[40:41], v[152:153] op_sel_hi:[0,1,1]
    v_pk_fma_f32 v[94:95], v[20:21], v[42:43], v[154:155] op_sel_hi:[0,1,1]
    v_pk_fma_f32 v[96:97], v[20:21], v[48:49], v[168:169] op_sel_hi:[0,1,1]
    v_pk_fma_f32 v[98:99], v[20:21], v[50:51], v[170:171] op_sel_hi:[0,1,1]
    v_pk_fma_f32 v[100:101], v[20:21], v[56:57], v[184:185] op_sel_hi:[0,1,1]
    v_pk_fma_f32 v[102:103], v[20:21], v[58:59], v[186:187] op_sel_hi:[0,1,1]
    v_pk_fma_f32 v[88:89], v[28:29], v[88:89], v[36:37] op_sel_hi:[0,1,1]
    v_pk_fma_f32 v[90:91], v[20:21], v[90:91], v[38:39] op_sel:[1,0,0] op_sel_hi:[1,1,1]
    v_pk_fma_f32 v[92:93], v[28:29], v[92:93], v[44:45] op_sel_hi:[0,1,1]
    v_pk_fma_f32 v[94:95], v[20:21], v[94:95], v[46:47] op_sel:[1,0,0] op_sel_hi:[1,1,1]
    v_pk_fma_f32 v[96:97], v[28:29], v[96:97], v[52:53] op_sel_hi:[0,1,1]
    v_pk_fma_f32 v[98:99], v[20:21], v[98:99], v[54:55] op_sel:[1,0,0] op_sel_hi:[1,1,1]
    v_pk_fma_f32 v[100:101], v[28:29], v[100:101], v[60:61] op_sel_hi:[0,1,1]
    v_pk_fma_f32 v[102:103], v[20:21], v[102:103], v[62:63] op_sel:[1,0,0] op_sel_hi:[1,1,1]
    v_exp_f32 v88, v88
    v_exp_f32 v89, v89
    v_exp_f32 v92, v92
    v_exp_f32 v93, v93
    v_exp_f32 v96, v96
    v_exp_f32 v97, v97
    v_exp_f32 v100, v100
    v_exp_f32 v101, v101
    v_pk_add_f32 v[88:89], v[88:89], 1.0 op_sel_hi:[1,0]
    v_pk_add_f32 v[92:93], v[92:93], 1.0 op_sel_hi:[1,0]
    v_pk_add_f32 v[96:97], v[96:97], 1.0 op_sel_hi:[1,0]
    v_pk_add_f32 v[100:101], v[100:101], 1.0 op_sel_hi:[1,0]
    v_rcp_f32 v88, v88
    v_rcp_f32 v89, v89
    v_rcp_f32 v92, v92
    v_rcp_f32 v93, v93
    v_rcp_f32 v96, v96
    v_rcp_f32 v97, v97
    v_rcp_f32 v100, v100
    v_rcp_f32 v101, v101
    v_pk_mul_f32 v[88:89], v[88:89], v[90:91]
    v_pk_mul_f32 v[92:93], v[92:93], v[94:95]
    v_pk_mul_f32 v[96:97], v[96:97], v[98:99]
    v_pk_mul_f32 v[100:101], v[100:101], v[102:103]
    v_cvt_pk_bf16_f32 v116, v88, v89
    v_cvt_pk_bf16_f32 v117, v92, v93
    v_cvt_pk_bf16_f32 v118, v96, v97
    v_cvt_pk_bf16_f32 v119, v100, v101
    buffer_store_dwordx4 v[116:119], v12, s[8:11], s34 offen sc1
    v_pk_fma_f32 v[88:89], v[20:21], v[64:65], v[200:201] op_sel_hi:[0,1,1]
    v_pk_fma_f32 v[90:91], v[20:21], v[66:67], v[202:203] op_sel_hi:[0,1,1]
    v_pk_fma_f32 v[92:93], v[20:21], v[72:73], v[216:217] op_sel_hi:[0,1,1]
    v_pk_fma_f32 v[94:95], v[20:21], v[74:75], v[218:219] op_sel_hi:[0,1,1]
    v_pk_fma_f32 v[96:97], v[20:21], v[80:81], v[232:233] op_sel_hi:[0,1,1]
    v_pk_fma_f32 v[98:99], v[20:21], v[82:83], v[234:235] op_sel_hi:[0,1,1]
    v_pk_fma_f32 v[88:89], v[28:29], v[88:89], v[68:69] op_sel_hi:[0,1,1]
    v_pk_fma_f32 v[90:91], v[20:21], v[90:91], v[70:71] op_sel:[1,0,0] op_sel_hi:[1,1,1]
    v_pk_fma_f32 v[92:93], v[28:29], v[92:93], v[76:77] op_sel_hi:[0,1,1]
    v_pk_fma_f32 v[94:95], v[20:21], v[94:95], v[78:79] op_sel:[1,0,0] op_sel_hi:[1,1,1]
    v_pk_fma_f32 v[96:97], v[28:29], v[96:97], v[84:85] op_sel_hi:[0,1,1]
    v_pk_fma_f32 v[98:99], v[20:21], v[98:99], v[86:87] op_sel:[1,0,0] op_sel_hi:[1,1,1]
    v_exp_f32 v88, v88
    v_exp_f32 v89, v89
    v_exp_f32 v92, v92
    v_exp_f32 v93, v93
    v_exp_f32 v96, v96
    v_exp_f32 v97, v97
    v_pk_add_f32 v[88:89], v[88:89], 1.0 op_sel_hi:[1,0]
    v_pk_add_f32 v[92:93], v[92:93], 1.0 op_sel_hi:[1,0]
    v_pk_add_f32 v[96:97], v[96:97], 1.0 op_sel_hi:[1,0]
    v_rcp_f32 v88, v88
    v_rcp_f32 v89, v89
    v_rcp_f32 v92, v92
    v_rcp_f32 v93, v93
    v_rcp_f32 v96, v96
    v_rcp_f32 v97, v97
    v_pk_mul_f32 v[88:89], v[88:89], v[90:91]
    v_pk_mul_f32 v[92:93], v[92:93], v[94:95]
    v_pk_mul_f32 v[96:97], v[96:97], v[98:99]
    v_cvt_pk_bf16_f32 v120, v88, v89
    v_cvt_pk_bf16_f32 v121, v92, v93
    v_cvt_pk_bf16_f32 v122, v96, v97
    buffer_store_dwordx3 v[120:122], v15, s[8:11], s34 offen offset:1024 sc1
    v_pk_fma_f32 v[88:89], v[22:23], v[32:33], v[140:141] op_sel_hi:[0,1,1]
    v_pk_fma_f32 v[90:91], v[22:23], v[34:35], v[142:143] op_sel_hi:[0,1,1]
    v_pk_fma_f32 v[92:93], v[22:23], v[40:41], v[156:157] op_sel_hi:[0,1,1]
    v_pk_fma_f32 v[94:95], v[22:23], v[42:43], v[158:159] op_sel_hi:[0,1,1]
    v_pk_fma_f32 v[96:97], v[22:23], v[48:49], v[172:173] op_sel_hi:[0,1,1]
    v_pk_fma_f32 v[98:99], v[22:23], v[50:51], v[174:175] op_sel_hi:[0,1,1]
    v_pk_fma_f32 v[100:101], v[22:23], v[56:57], v[188:189] op_sel_hi:[0,1,1]
    v_pk_fma_f32 v[102:103], v[22:23], v[58:59], v[190:191] op_sel_hi:[0,1,1]
    v_pk_fma_f32 v[88:89], v[30:31], v[88:89], v[36:37] op_sel_hi:[0,1,1]
    v_pk_fma_f32 v[90:91], v[22:23], v[90:91], v[38:39] op_sel:[1,0,0] op_sel_hi:[1,1,1]
    v_pk_fma_f32 v[92:93], v[30:31], v[92:93], v[44:45] op_sel_hi:[0,1,1]
    v_pk_fma_f32 v[94:95], v[22:23], v[94:95], v[46:47] op_sel:[1,0,0] op_sel_hi:[1,1,1]
    v_pk_fma_f32 v[96:97], v[30:31], v[96:97], v[52:53] op_sel_hi:[0,1,1]
    v_pk_fma_f32 v[98:99], v[22:23], v[98:99], v[54:55] op_sel:[1,0,0] op_sel_hi:[1,1,1]
    v_pk_fma_f32 v[100:101], v[30:31], v[100:101], v[60:61] op_sel_hi:[0,1,1]
    v_pk_fma_f32 v[102:103], v[22:23], v[102:103], v[62:63] op_sel:[1,0,0] op_sel_hi:[1,1,1]
    v_exp_f32 v88, v88
    v_exp_f32 v89, v89
    v_exp_f32 v92, v92
    v_exp_f32 v93, v93
    v_exp_f32 v96, v96
    v_exp_f32 v97, v97
    v_exp_f32 v100, v100
    v_exp_f32 v101, v101
    v_pk_add_f32 v[88:89], v[88:89], 1.0 op_sel_hi:[1,0]
    v_pk_add_f32 v[92:93], v[92:93], 1.0 op_sel_hi:[1,0]
    v_pk_add_f32 v[96:97], v[96:97], 1.0 op_sel_hi:[1,0]
    v_pk_add_f32 v[100:101], v[100:101], 1.0 op_sel_hi:[1,0]
    v_rcp_f32 v88, v88
    v_rcp_f32 v89, v89
    v_rcp_f32 v92, v92
    v_rcp_f32 v93, v93
    v_rcp_f32 v96, v96
    v_rcp_f32 v97, v97
    v_rcp_f32 v100, v100
    v_rcp_f32 v101, v101
    v_pk_mul_f32 v[88:89], v[88:89], v[90:91]
    v_pk_mul_f32 v[92:93], v[92:93], v[94:95]
    v_pk_mul_f32 v[96:97], v[96:97], v[98:99]
    v_pk_mul_f32 v[100:101], v[100:101], v[102:103]
    v_cvt_pk_bf16_f32 v104, v88, v89
    v_cvt_pk_bf16_f32 v105, v92, v93
    v_cvt_pk_bf16_f32 v106, v96, v97
    v_cvt_pk_bf16_f32 v107, v100, v101
    buffer_store_dwordx4 v[104:107], v12, s[8:11], s35 offen sc1
    v_pk_fma_f32 v[88:89], v[22:23], v[64:65], v[204:205] op_sel_hi:[0,1,1]
    v_pk_fma_f32 v[90:91], v[22:23], v[66:67], v[206:207] op_sel_hi:[0,1,1]
    v_pk_fma_f32 v[92:93], v[22:23], v[72:73], v[220:221] op_sel_hi:[0,1,1]
    v_pk_fma_f32 v[94:95], v[22:23], v[74:75], v[222:223] op_sel_hi:[0,1,1]
    v_pk_fma_f32 v[96:97], v[22:23], v[80:81], v[236:237] op_sel_hi:[0,1,1]
    v_pk_fma_f32 v[98:99], v[22:23], v[82:83], v[238:239] op_sel_hi:[0,1,1]
    v_pk_fma_f32 v[88:89], v[30:31], v[88:89], v[68:69] op_sel_hi:[0,1,1]
    v_pk_fma_f32 v[90:91], v[22:23], v[90:91], v[70:71] op_sel:[1,0,0] op_sel_hi:[1,1,1]
    v_pk_fma_f32 v[92:93], v[30:31], v[92:93], v[76:77] op_sel_hi:[0,1,1]
    v_pk_fma_f32 v[94:95], v[22:23], v[94:95], v[78:79] op_sel:[1,0,0] op_sel_hi:[1,1,1]
    v_pk_fma_f32 v[96:97], v[30:31], v[96:97], v[84:85] op_sel_hi:[0,1,1]
    v_pk_fma_f32 v[98:99], v[22:23], v[98:99], v[86:87] op_sel:[1,0,0] op_sel_hi:[1,1,1]
    v_exp_f32 v88, v88
    v_exp_f32 v89, v89
    v_exp_f32 v92, v92
    v_exp_f32 v93, v93
    v_exp_f32 v96, v96
    v_exp_f32 v97, v97
    v_pk_add_f32 v[88:89], v[88:89], 1.0 op_sel_hi:[1,0]
    v_pk_add_f32 v[92:93], v[92:93], 1.0 op_sel_hi:[1,0]
    v_pk_add_f32 v[96:97], v[96:97], 1.0 op_sel_hi:[1,0]
    v_rcp_f32 v88, v88
    v_rcp_f32 v89, v89
    v_rcp_f32 v92, v92
    v_rcp_f32 v93, v93
    v_rcp_f32 v96, v96
    v_rcp_f32 v97, v97
    v_pk_mul_f32 v[88:89], v[88:89], v[90:91]
    v_pk_mul_f32 v[92:93], v[92:93], v[94:95]
    v_pk_mul_f32 v[96:97], v[96:97], v[98:99]
    v_cvt_pk_bf16_f32 v108, v88, v89
    v_cvt_pk_bf16_f32 v109, v92, v93
    v_cvt_pk_bf16_f32 v110, v96, v97
    buffer_store_dwordx3 v[108:110], v15, s[8:11], s35 offen offset:1024 sc1
    s_mov_b32 s31, s21
    s_branch L_g_join
L_g_loader:
    v_lshlrev_b32 v6, 1, v4
    v_xor_b32 v6, v6, v3
    v_lshlrev_b32 v6, 4, v6
    v_mul_u32_u24 v8, 4224, v4
    v_add_u32 v7, v8, v6
    v_xor_b32 v6, 128, v6
    v_add_u32 v8, v8, v6
    s_and_b32 s38, s18, 3
    s_mul_i32 s21, s38, 67584
    s_lshl_b32 s22, s16, 8
    s_add_u32 s21, s21, s22
    s_lshl_b32 s22, s38, 12
    s_add_u32 s22, s22, 28672
    v_and_b32 v9, 31, v2
    s_add_u32 s12, s4, 1048576
    s_addc_u32 s13, s5, 0
    s_mov_b32 s14, 2162688
    s_mov_b32 s15, 0x20000
    s_add_u32 s28, s4, 23199744
    s_addc_u32 s29, s5, 0
    s_mov_b32 s30, 458752
    s_mov_b32 s31, 0x20000
    s_add_u32 s52, s4, 23734272
    s_addc_u32 s53, s5, 0
    s_mov_b32 s54, 38912
    s_mov_b32 s55, 0x20000
    v_lshrrev_b32 v110, 5, v2
    v_lshl_add_u32 v109, v9, 3, v110
    s_lshl_b32 s38, s18, 1
    v_add_u32 v109, s38, v109
    v_lshlrev_b32 v109, 7, v109
    v_add_u32 v109, 24182784, v109
    v_min_u32 v9, 27, v9
    s_mul_i32 s25, s18, 28
    v_add_u32 v9, s25, v9
    v_lshlrev_b32 v10, 4, v9
    v_mul_u32_u24 v11, 229376, v110
    v_add_u32 v11, v11, v10
    s_mul_i32 s25, s17, 1792
    s_mul_i32 s36, s51, 229376
    s_mul_i32 s37, s18, 7168
    s_add_u32 s36, s36, s37
    v_lshrrev_b32 v41, 2, v2
    v_and_b32 v42, 3, v41
    v_bfe_u32 v43, v41, 3, 1
    v_lshl_or_b32 v42, v43, 2, v42
    v_lshlrev_b32 v42, 1, v42
    v_xor_b32 v42, s17, v42
    v_lshlrev_b32 v42, 4, v42
    v_lshl_add_u32 v40, v41, 8, v42
    v_and_b32 v42, 3, v2
    v_lshl_add_u32 v40, v42, 2, v40
    v_add_u32 v40, s22, v40
    v_mov_b32 v44, 0
    v_mov_b32 v45, 0
    v_mov_b32 v46, 0
    v_mov_b32 v47, 0
    buffer_load_dwordx4 v[192:195], v12, s[44:47], s40 offen offset:3584 sc1
    buffer_load_dwordx4 v[196:199], v12, s[44:47], s41 offen offset:3584 sc1
    buffer_load_dwordx4 v[200:203], v12, s[44:47], s42 offen offset:3584 sc1
    buffer_load_dwordx4 v[204:207], v12, s[44:47], s43 offen offset:3584 sc1
    s_add_u32 s56, s40, 4096
    buffer_load_dwordx3 v[208:210], v15, s[44:47], s56 offen offset:512 sc1
    s_add_u32 s56, s41, 4096
    buffer_load_dwordx3 v[212:214], v15, s[44:47], s56 offen offset:512 sc1
    s_add_u32 s56, s42, 4096
    buffer_load_dwordx3 v[216:218], v15, s[44:47], s56 offen offset:512 sc1
    s_add_u32 s56, s43, 4096
    buffer_load_dwordx3 v[220:222], v15, s[44:47], s56 offen offset:512 sc1
    s_add_u32 s56, s40, 4096
    buffer_load_dwordx4 v[224:227], v12, s[44:47], s56 offen offset:1280 sc1
    s_add_u32 s56, s41, 4096
    buffer_load_dwordx4 v[228:231], v12, s[44:47], s56 offen offset:1280 sc1
    s_add_u32 s56, s42, 4096
    buffer_load_dwordx4 v[232:235], v12, s[44:47], s56 offen offset:1280 sc1
    s_add_u32 s56, s43, 4096
    buffer_load_dwordx4 v[236:239], v12, s[44:47], s56 offen offset:1280 sc1
    s_add_u32 s56, s40, 4096
    buffer_load_dwordx3 v[240:242], v15, s[44:47], s56 offen offset:2304 sc1
    s_add_u32 s56, s41, 4096
    buffer_load_dwordx3 v[244:246], v15, s[44:47], s56 offen offset:2304 sc1
    s_add_u32 s56, s42, 4096
    buffer_load_dwordx3 v[248:250], v15, s[44:47], s56 offen offset:2304 sc1
    s_add_u32 s56, s43, 4096
    buffer_load_dwordx3 v[252:254], v15, s[44:47], s56 offen offset:2304 sc1
    s_waitcnt vmcnt(16)
    s_barrier
    s_add_u32 m0, s22, 0
    s_add_u32 s24, s21, 0
    buffer_load_dwordx4 v7, s[12:15], s24 offen sc1 lds
    s_add_u32 m0, s22, 1024
    s_add_u32 s24, s21, 16896
    buffer_load_dwordx4 v7, s[12:15], s24 offen sc1 lds
    s_add_u32 m0, s22, 2048
    s_add_u32 s24, s21, 33792
    buffer_load_dwordx4 v8, s[12:15], s24 offen sc1 lds
    s_add_u32 m0, s22, 3072
    s_add_u32 s24, s21, 50688
    buffer_load_dwordx4 v8, s[12:15], s24 offen sc1 lds
    s_add_u32 m0, s20, 0
    s_add_u32 s23, s20, 0
    buffer_load_dwordx4 v12, s[32:35], s23 offen offset:0 sc1 lds
    buffer_load_dwordx4 v12, s[32:35], s23 offen offset:1024 sc1 lds
    buffer_load_dwordx4 v12, s[32:35], s23 offen offset:2048 sc1 lds
    buffer_load_dwordx4 v12, s[32:35], s23 offen offset:3072 sc1 lds
    s_add_u32 m0, s20, 4096
    s_add_u32 s23, s20, 4096
    buffer_load_dwordx4 v12, s[32:35], s23 offen offset:0 sc1 lds
    buffer_load_dwordx4 v12, s[32:35], s23 offen offset:1024 sc1 lds
    buffer_load_dwordx4 v12, s[32:35], s23 offen offset:2048 sc1 lds
    s_add_u32 m0, s22, 45056
    s_add_u32 s24, s21, 270336
    buffer_load_dwordx4 v7, s[12:15], s24 offen sc1 lds
    s_add_u32 m0, s22, 46080
    s_add_u32 s24, s21, 287232
    buffer_load_dwordx4 v7, s[12:15], s24 offen sc1 lds
    s_add_u32 m0, s22, 47104
    s_add_u32 s24, s21, 304128
    buffer_load_dwordx4 v8, s[12:15], s24 offen sc1 lds
    s_add_u32 m0, s22, 48128
    s_add_u32 s24, s21, 321024
    buffer_load_dwordx4 v8, s[12:15], s24 offen sc1 lds
    s_add_u32 m0, s20, 45056
    s_add_u32 s23, s20, 28672
    buffer_load_dwordx4 v12, s[32:35], s23 offen offset:0 sc1 lds
    buffer_load_dwordx4 v12, s[32:35], s23 offen offset:1024 sc1 lds
    buffer_load_dwordx4 v12, s[32:35], s23 offen offset:2048 sc1 lds
    buffer_load_dwordx4 v12, s[32:35], s23 offen offset:3072 sc1 lds
    s_add_u32 m0, s20, 49152
    s_add_u32 s23, s20, 32768
    buffer_load_dwordx4 v12, s[32:35], s23 offen offset:0 sc1 lds
    buffer_load_dwordx4 v12, s[32:35], s23 offen offset:1024 sc1 lds
    buffer_load_dwordx4 v12, s[32:35], s23 offen offset:2048 sc1 lds
    s_waitcnt vmcnt(11)
    v_add_u32 v41, 0, v40
    ds_read_b32 v42, v41
    s_waitcnt lgkmcnt(0)
    v_lshlrev_b32 v43, 16, v42
    v_and_b32 v42, v1, v42
    v_add_f32 v44, v44, v43
    v_add_f32 v45, v45, v42
    v_fmac_f32 v46, v43, v43
    v_fmac_f32 v47, v42, v42
    s_barrier
    s_add_u32 m0, s22, 90112
    s_add_u32 s24, s21, 540672
    buffer_load_dwordx4 v7, s[12:15], s24 offen sc1 lds
    s_add_u32 m0, s22, 91136
    s_add_u32 s24, s21, 557568
    buffer_load_dwordx4 v7, s[12:15], s24 offen sc1 lds
    s_add_u32 m0, s22, 92160
    s_add_u32 s24, s21, 574464
    buffer_load_dwordx4 v8, s[12:15], s24 offen sc1 lds
    s_add_u32 m0, s22, 93184
    s_add_u32 s24, s21, 591360
    buffer_load_dwordx4 v8, s[12:15], s24 offen sc1 lds
    s_add_u32 m0, s20, 90112
    s_add_u32 s23, s20, 57344
    buffer_load_dwordx4 v12, s[32:35], s23 offen offset:0 sc1 lds
    buffer_load_dwordx4 v12, s[32:35], s23 offen offset:1024 sc1 lds
    buffer_load_dwordx4 v12, s[32:35], s23 offen offset:2048 sc1 lds
    buffer_load_dwordx4 v12, s[32:35], s23 offen offset:3072 sc1 lds
    s_add_u32 m0, s20, 94208
    s_add_u32 s23, s20, 61440
    buffer_load_dwordx4 v12, s[32:35], s23 offen offset:0 sc1 lds
    buffer_load_dwordx4 v12, s[32:35], s23 offen offset:1024 sc1 lds
    buffer_load_dwordx4 v12, s[32:35], s23 offen offset:2048 sc1 lds
    s_waitcnt vmcnt(11)
    v_add_u32 v41, 45056, v40
    ds_read_b32 v42, v41
    s_waitcnt lgkmcnt(0)
    v_lshlrev_b32 v43, 16, v42
    v_and_b32 v42, v1, v42
    v_add_f32 v44, v44, v43
    v_add_f32 v45, v45, v42
    v_fmac_f32 v46, v43, v43
    v_fmac_f32 v47, v42, v42
    s_barrier
    s_cmp_lg_u32 s18, 0
    s_cbranch_scc1 L_g_bl0
    global_load_dword v110, v109, s[4:5] sc1
L_g_bl0:
    s_add_u32 m0, s22, 0
    s_add_u32 s24, s21, 811008
    buffer_load_dwordx4 v7, s[12:15], s24 offen sc1 lds
    s_add_u32 m0, s22, 1024
    s_add_u32 s24, s21, 827904
    buffer_load_dwordx4 v7, s[12:15], s24 offen sc1 lds
    s_add_u32 m0, s22, 2048
    s_add_u32 s24, s21, 844800
    buffer_load_dwordx4 v8, s[12:15], s24 offen sc1 lds
    s_add_u32 m0, s22, 3072
    s_add_u32 s24, s21, 861696
    buffer_load_dwordx4 v8, s[12:15], s24 offen sc1 lds
    s_add_u32 m0, s20, 0
    s_add_u32 s23, s20, 86016
    buffer_load_dwordx4 v12, s[32:35], s23 offen offset:0 sc1 lds
    buffer_load_dwordx4 v12, s[32:35], s23 offen offset:1024 sc1 lds
    buffer_load_dwordx4 v12, s[32:35], s23 offen offset:2048 sc1 lds
    buffer_load_dwordx4 v12, s[32:35], s23 offen offset:3072 sc1 lds
    s_add_u32 m0, s20, 4096
    s_add_u32 s23, s20, 90112
    buffer_load_dwordx4 v12, s[32:35], s23 offen offset:0 sc1 lds
    buffer_load_dwordx4 v12, s[32:35], s23 offen offset:1024 sc1 lds
    buffer_load_dwordx4 v12, s[32:35], s23 offen offset:2048 sc1 lds
    s_waitcnt vmcnt(11)
    v_add_u32 v41, 90112, v40
    ds_read_b32 v42, v41
    s_waitcnt lgkmcnt(0)
    v_lshlrev_b32 v43, 16, v42
    v_and_b32 v42, v1, v42
    v_add_f32 v44, v44, v43
    v_add_f32 v45, v45, v42
    v_fmac_f32 v46, v43, v43
    v_fmac_f32 v47, v42, v42
    s_cmp_lg_u32 s18, 0
    s_cbranch_scc1 L_g_bp0ok
    s_waitcnt vmcnt(11)
    s_mov_b32 s61, 0x40000
L_g_bp0:
    v_cmp_ne_u32 vcc, s60, v110
    s_cbranch_vccz L_g_bp0ok
    s_sleep 1
    global_load_dword v110, v109, s[4:5] sc1
    s_waitcnt vmcnt(0)
    s_sub_u32 s61, s61, 1
    s_cbranch_scc0 L_g_bp0
L_g_bp0ok:
    s_barrier
    s_cmp_lg_u32 s18, 1
    s_cbranch_scc1 L_g_bl1
    global_load_dword v110, v109, s[4:5] sc1
L_g_bl1:
    s_cmp_lg_u32 s18, 3
    s_cbranch_scc1 L_g_bl3
    global_load_dword v110, v109, s[4:5] sc1
L_g_bl3:
    s_add_u32 m0, s22, 45056
    s_add_u32 s24, s21, 1081344
    buffer_load_dwordx4 v7, s[12:15], s24 offen sc1 lds
    s_add_u32 m0, s22, 46080
    s_add_u32 s24, s21, 1098240
    buffer_load_dwordx4 v7, s[12:15], s24 offen sc1 lds
    s_add_u32 m0, s22, 47104
    s_add_u32 s24, s21, 1115136
    buffer_load_dwordx4 v8, s[12:15], s24 offen sc1 lds
    s_add_u32 m0, s22, 48128
    s_add_u32 s24, s21, 1132032
    buffer_load_dwordx4 v8, s[12:15], s24 offen sc1 lds
    s_add_u32 m0, s20, 45056
    s_add_u32 s23, s20, 114688
    buffer_load_dwordx4 v12, s[32:35], s23 offen offset:0 sc1 lds
    buffer_load_dwordx4 v12, s[32:35], s23 offen offset:1024 sc1 lds
    buffer_load_dwordx4 v12, s[32:35], s23 offen offset:2048 sc1 lds
    buffer_load_dwordx4 v12, s[32:35], s23 offen offset:3072 sc1 lds
    s_add_u32 m0, s20, 49152
    s_add_u32 s23, s20, 118784
    buffer_load_dwordx4 v12, s[32:35], s23 offen offset:0 sc1 lds
    buffer_load_dwordx4 v12, s[32:35], s23 offen offset:1024 sc1 lds
    buffer_load_dwordx4 v12, s[32:35], s23 offen offset:2048 sc1 lds
    s_waitcnt vmcnt(11)
    v_add_u32 v41, 0, v40
    ds_read_b32 v42, v41
    s_waitcnt lgkmcnt(0)
    v_lshlrev_b32 v43, 16, v42
    v_and_b32 v42, v1, v42
    v_add_f32 v44, v44, v43
    v_add_f32 v45, v45, v42
    v_fmac_f32 v46, v43, v43
    v_fmac_f32 v47, v42, v42
    s_cmp_lg_u32 s18, 1
    s_cbranch_scc1 L_g_bp1ok
    s_waitcnt vmcnt(11)
    s_mov_b32 s61, 0x40000
L_g_bp1:
    v_cmp_ne_u32 vcc, s60, v110
    s_cbranch_vccz L_g_bp1ok
    s_sleep 1
    global_load_dword v110, v109, s[4:5] sc1
    s_waitcnt vmcnt(0)
    s_sub_u32 s61, s61, 1
    s_cbranch_scc0 L_g_bp1
L_g_bp1ok:
    s_cmp_lg_u32 s18, 3
    s_cbranch_scc1 L_g_bp3ok
    s_waitcnt vmcnt(11)
    s_mov_b32 s61, 0x40000
L_g_bp3:
    v_cmp_ne_u32 vcc, s60, v110
    s_cbranch_vccz L_g_bp3ok
    s_sleep 1
    global_load_dword v110, v109, s[4:5] sc1
    s_waitcnt vmcnt(0)
    s_sub_u32 s61, s61, 1
    s_cbranch_scc0 L_g_bp3
L_g_bp3ok:
    s_barrier
    s_cmp_lg_u32 s18, 2
    s_cbranch_scc1 L_g_bl2
    global_load_dword v110, v109, s[4:5] sc1
L_g_bl2:
    s_add_u32 m0, s22, 90112
    s_add_u32 s24, s21, 1351680
    buffer_load_dwordx4 v7, s[12:15], s24 offen sc1 lds
    s_add_u32 m0, s22, 91136
    s_add_u32 s24, s21, 1368576
    buffer_load_dwordx4 v7, s[12:15], s24 offen sc1 lds
    s_add_u32 m0, s22, 92160
    s_add_u32 s24, s21, 1385472
    buffer_load_dwordx4 v8, s[12:15], s24 offen sc1 lds
    s_add_u32 m0, s22, 93184
    s_add_u32 s24, s21, 1402368
    buffer_load_dwordx4 v8, s[12:15], s24 offen sc1 lds
    s_add_u32 m0, s20, 90112
    s_add_u32 s23, s20, 143360
    buffer_load_dwordx4 v12, s[32:35], s23 offen offset:0 sc1 lds
    buffer_load_dwordx4 v12, s[32:35], s23 offen offset:1024 sc1 lds
    buffer_load_dwordx4 v12, s[32:35], s23 offen offset:2048 sc1 lds
    buffer_load_dwordx4 v12, s[32:35], s23 offen offset:3072 sc1 lds
    s_add_u32 m0, s20, 94208
    s_add_u32 s23, s20, 147456
    buffer_load_dwordx4 v12, s[32:35], s23 offen offset:0 sc1 lds
    buffer_load_dwordx4 v12, s[32:35], s23 offen offset:1024 sc1 lds
    buffer_load_dwordx4 v12, s[32:35], s23 offen offset:2048 sc1 lds
    s_add_u32 m0, s22, 106496
    s_add_u32 s24, s21, 1892352
    buffer_load_dwordx4 v7, s[12:15], s24 offen sc1 lds
    s_add_u32 m0, s22, 107520
    s_add_u32 s24, s21, 1909248
    buffer_load_dwordx4 v7, s[12:15], s24 offen sc1 lds
    s_add_u32 m0, s22, 108544
    s_add_u32 s24, s21, 1926144
    buffer_load_dwordx4 v8, s[12:15], s24 offen sc1 lds
    s_add_u32 m0, s22, 109568
    s_add_u32 s24, s21, 1943040
    buffer_load_dwordx4 v8, s[12:15], s24 offen sc1 lds
    s_waitcnt vmcnt(15)
    v_add_u32 v41, 45056, v40
    ds_read_b32 v42, v41
    s_waitcnt lgkmcnt(0)
    v_lshlrev_b32 v43, 16, v42
    v_and_b32 v42, v1, v42
    v_add_f32 v44, v44, v43
    v_add_f32 v45, v45, v42
    v_fmac_f32 v46, v43, v43
    v_fmac_f32 v47, v42, v42
    s_cmp_lg_u32 s18, 2
    s_cbranch_scc1 L_g_bp2ok
    s_waitcnt vmcnt(11)
    s_mov_b32 s61, 0x40000
L_g_bp2:
    v_cmp_ne_u32 vcc, s60, v110
    s_cbranch_vccz L_g_bp2ok
    s_sleep 1
    global_load_dword v110, v109, s[4:5] sc1
    s_waitcnt vmcnt(0)
    s_sub_u32 s61, s61, 1
    s_cbranch_scc0 L_g_bp2
L_g_bp2ok:
    s_barrier
    s_add_u32 m0, s22, 0
    s_add_u32 s24, s21, 1622016
    buffer_load_dwordx4 v7, s[12:15], s24 offen sc1 lds
    s_add_u32 m0, s22, 1024
    s_add_u32 s24, s21, 1638912
    buffer_load_dwordx4 v7, s[12:15], s24 offen sc1 lds
    s_add_u32 m0, s22, 2048
    s_add_u32 s24, s21, 1655808
    buffer_load_dwordx4 v8, s[12:15], s24 offen sc1 lds
    s_add_u32 m0, s22, 3072
    s_add_u32 s24, s21, 1672704
    buffer_load_dwordx4 v8, s[12:15], s24 offen sc1 lds
    s_add_u32 m0, s20, 0
    s_add_u32 s23, s20, 172032
    buffer_load_dwordx4 v12, s[32:35], s23 offen offset:0 sc1 lds
    buffer_load_dwordx4 v12, s[32:35], s23 offen offset:1024 sc1 lds
    buffer_load_dwordx4 v12, s[32:35], s23 offen offset:2048 sc1 lds
    buffer_load_dwordx4 v12, s[32:35], s23 offen offset:3072 sc1 lds
    s_add_u32 m0, s20, 4096
    s_add_u32 s23, s20, 176128
    buffer_load_dwordx4 v12, s[32:35], s23 offen offset:0 sc1 lds
    buffer_load_dwordx4 v12, s[32:35], s23 offen offset:1024 sc1 lds
    buffer_load_dwordx4 v12, s[32:35], s23 offen offset:2048 sc1 lds
    s_waitcnt vmcnt(11)
    v_add_u32 v41, 90112, v40
    ds_read_b32 v42, v41
    s_waitcnt lgkmcnt(0)
    v_lshlrev_b32 v43, 16, v42
    v_and_b32 v42, v1, v42
    v_add_f32 v44, v44, v43
    v_add_f32 v45, v45, v42
    v_fmac_f32 v46, v43, v43
    v_fmac_f32 v47, v42, v42
    v_add_u32 v41, 106496, v40
    ds_read_b32 v42, v41
    s_waitcnt lgkmcnt(0)
    v_lshlrev_b32 v43, 16, v42
    v_and_b32 v42, v1, v42
    v_add_f32 v44, v44, v43
    v_add_f32 v45, v45, v42
    v_fmac_f32 v46, v43, v43
    v_fmac_f32 v47, v42, v42
    s_barrier
    s_add_u32 m0, s20, 45056
    s_add_u32 s23, s20, 200704
    buffer_load_dwordx4 v12, s[32:35], s23 offen offset:0 sc1 lds
    buffer_load_dwordx4 v12, s[32:35], s23 offen offset:1024 sc1 lds
    buffer_load_dwordx4 v12, s[32:35], s23 offen offset:2048 sc1 lds
    buffer_load_dwordx4 v12, s[32:35], s23 offen offset:3072 sc1 lds
    s_add_u32 m0, s20, 49152
    s_add_u32 s23, s20, 204800
    buffer_load_dwordx4 v12, s[32:35], s23 offen offset:0 sc1 lds
    buffer_load_dwordx4 v12, s[32:35], s23 offen offset:1024 sc1 lds
    buffer_load_dwordx4 v12, s[32:35], s23 offen offset:2048 sc1 lds
    s_setprio 3
    s_waitcnt vmcnt(14)
    v_add_u32 v41, 0, v40
    ds_read_b32 v42, v41
    s_waitcnt lgkmcnt(0)
    v_lshlrev_b32 v43, 16, v42
    v_and_b32 v42, v1, v42
    v_add_f32 v44, v44, v43
    v_add_f32 v45, v45, v42
    v_fmac_f32 v46, v43, v43
    v_fmac_f32 v47, v42, v42
    v_add_f32_dpp v44, v44, v44 row_ror:8 row_mask:0xf bank_mask:0xf
    v_add_f32_dpp v45, v45, v45 row_ror:8 row_mask:0xf bank_mask:0xf
    v_add_f32_dpp v46, v46, v46 row_ror:8 row_mask:0xf bank_mask:0xf
    v_add_f32_dpp v47, v47, v47 row_ror:8 row_mask:0xf bank_mask:0xf
    v_add_f32_dpp v44, v44, v44 row_ror:4 row_mask:0xf bank_mask:0xf
    v_add_f32_dpp v45, v45, v45 row_ror:4 row_mask:0xf bank_mask:0xf
    v_add_f32_dpp v46, v46, v46 row_ror:4 row_mask:0xf bank_mask:0xf
    v_add_f32_dpp v47, v47, v47 row_ror:4 row_mask:0xf bank_mask:0xf
    s_nop 0
    v_permlane32_swap_b32 v44, v46
    v_permlane32_swap_b32 v45, v47
    v_add_f32 v44, v44, v46
    v_add_f32 v45, v45, v47
    v_mov_b32 v46, v44
    v_mov_b32 v47, v45
    s_nop 0
    v_permlane16_swap_b32 v44, v46
    v_permlane16_swap_b32 v45, v47
    v_add_f32 v44, v44, v46
    v_add_f32 v45, v45, v47
    v_and_b32 v41, 3, v2
    v_lshlrev_b32 v41, 3, v41
    v_lshrrev_b32 v42, 5, v2
    v_lshl_add_u32 v41, v42, 5, v41
    s_lshl_b32 s38, s18, 6
    s_add_u32 s38, s38, 160064
    v_add_u32 v41, s38, v41
    ds_write_b64 v41, v[44:45]
    v_mov_b32 v41, 160016
    v_mov_b32 v42, 1
    s_waitcnt lgkmcnt(0)
    s_mov_b64 exec, 1
    ds_add_rtn_u32 v42, v41, v42
    s_mov_b64 exec, -1
    s_waitcnt lgkmcnt(0)
    v_readfirstlane_b32 s38, v42
    s_nop 1
    s_cmp_lg_u32 s38, 3
    s_cbranch_scc1 L_g_nost
    v_and_b32 v101, 7, v2
    v_lshlrev_b32 v100, 2, v101
    v_add_u32 v100, 160064, v100
    ds_read_b32 v16, v100 offset:0
    ds_read_b32 v20, v100 offset:32
    ds_read_b32 v17, v100 offset:64
    ds_read_b32 v21, v100 offset:96
    ds_read_b32 v18, v100 offset:128
    ds_read_b32 v22, v100 offset:160
    ds_read_b32 v19, v100 offset:192
    ds_read_b32 v23, v100 offset:224
    s_lshl_b32 s38, s16, 11
    s_lshl_b32 s39, s17, 7
    s_add_u32 s38, s38, s39
    s_add_u32 s38, s38, 24346624
    v_lshl_add_u32 v100, v101, 4, s38
    v_mov_b32 v26, s60
    v_mov_b32 v27, s60
    s_waitcnt lgkmcnt(0)
    v_add_f32 v16, v16, v17
    v_add_f32 v18, v18, v19
    v_add_f32 v20, v20, v21
    v_add_f32 v22, v22, v23
    v_add_f32 v16, v16, v18
    v_add_f32 v20, v20, v22
    v_mul_f32 v16, 0x3b000000, v16
    v_mul_f32 v20, 0x3b000000, v20
    v_fma_f32 v20, -v16, v16, v20
    v_max_f32 v20, 0, v20
    v_cvt_pk_bf16_f32 v17, v20, -v16
    v_and_b32 v24, v1, v17
    v_lshlrev_b32 v20, 16, v17
    v_add_f32 v20, 0x3727c5ac, v20
    v_cvt_pk_bf16_f32 v17, v20, v20
    v_and_b32 v20, v1, v17
    v_sqrt_f32 v20, v20
    s_nop 0
    v_cvt_pk_bf16_f32 v17, v20, v20
    v_and_b32 v20, v1, v17
    v_rcp_f32 v25, v20
    s_mov_b64 exec, 0xff
    global_store_dwordx4 v100, v[24:27], s[4:5] sc1
    s_mov_b64 exec, -1
L_g_nost:
    s_setprio 0
    buffer_load_dwordx4 v[64:67], v11, s[28:31], s25 offen sc1
    s_add_u32 s25, s25, 28672
    buffer_load_dwordx4 v[68:71], v11, s[28:31], s25 offen sc1
    s_add_u32 s25, s25, 28672
    buffer_load_dwordx4 v[72:75], v11, s[28:31], s25 offen sc1
    s_add_u32 s25, s25, 28672
    buffer_load_dwordx4 v[76:79], v11, s[28:31], s25 offen sc1
    s_add_u32 s25, s25, 28672
    buffer_load_dwordx4 v[80:83], v11, s[28:31], s25 offen sc1
    s_add_u32 s25, s25, 28672
    buffer_load_dwordx4 v[84:87], v11, s[28:31], s25 offen sc1
    s_add_u32 s25, s25, 28672
    buffer_load_dwordx4 v[88:91], v11, s[28:31], s25 offen sc1
    s_add_u32 s25, s25, 28672
    buffer_load_dwordx4 v[92:95], v11, s[28:31], s25 offen sc1
    s_add_u32 s25, s25, 28672
    v_lshlrev_b32 v108, 2, v2
    s_lshl_b32 s38, s51, 8
    buffer_load_dword v102, v108, s[52:55], s38 offen sc1
    s_add_u32 s38, s38, 12288
    buffer_load_dword v103, v108, s[52:55], s38 offen sc1
    s_add_u32 s38, s38, 12288
    buffer_load_dword v104, v108, s[52:55], s38 offen sc1
    s_add_u32 s38, s38, 12288
    buffer_load_dword v105, v108, s[52:55], s38 offen sc1
    s_add_u32 s38, s38, 12288
    s_waitcnt vmcnt(19)
    s_barrier
    s_waitcnt vmcnt(12)
    v_mov_b32 v41, 160000
    v_mov_b32 v42, 1
    s_mov_b64 exec, 1
    ds_add_u32 v41, v42 offset:32
    s_mov_b64 exec, -1
    s_setprio 3
    v_lshrrev_b32 v100, 4, v2
    v_bfe_u32 v101, v2, 3, 1
    v_lshl_add_u32 v100, v101, 8, v100
    v_mul_u32_u24 v100, 4224, v100
    v_and_b32 v101, 7, v2
    v_lshl_add_u32 v100, v101, 4, v100
    s_mul_i32 s38, s51, 135168
    s_mul_i32 s39, s18, 33792
    s_add_u32 s38, s38, s39
    s_lshl_b32 s39, s50, 7
    s_add_u32 s38, s38, s39
    s_lshl_b32 s39, s18, 11
    s_add_u32 m0, s39, 151552
    s_nop 0
    buffer_load_dwordx4 v100, s[12:15], s38 offen sc1 lds
    s_add_u32 m0, s39, 152576
    s_add_u32 s38, s38, 16896
    buffer_load_dwordx4 v100, s[12:15], s38 offen sc1 lds
    v_mov_b32 v41, 160000
    s_cmp_eq_u32 s18, 3
    s_cbranch_scc1 L_g_h3
    s_add_u32 m0, s37, 73728
    s_add_u32 s23, s36, 0
    buffer_load_dwordx4 v12, s[44:47], s23 offen offset:0 sc1 lds
    buffer_load_dwordx4 v12, s[44:47], s23 offen offset:1024 sc1 lds
    buffer_load_dwordx4 v12, s[44:47], s23 offen offset:2048 sc1 lds
    buffer_load_dwordx4 v12, s[44:47], s23 offen offset:3072 sc1 lds
    s_add_u32 m0, s37, 77824
    s_add_u32 s23, s36, 4096
    buffer_load_dwordx4 v12, s[44:47], s23 offen offset:0 sc1 lds
    buffer_load_dwordx4 v12, s[44:47], s23 offen offset:1024 sc1 lds
    buffer_load_dwordx4 v12, s[44:47], s23 offen offset:2048 sc1 lds
    s_waitcnt vmcnt(9)
    v_add_f32 v64, v64, v68
    v_add_f32 v65, v65, v69
    v_add_f32 v66, v66, v70
    v_add_f32 v67, v67, v71
    v_add_f32 v64, v64, v72
    v_add_f32 v65, v65, v73
    v_add_f32 v66, v66, v74
    v_add_f32 v67, v67, v75
    v_add_f32 v64, v64, v76
    v_add_f32 v65, v65, v77
    v_add_f32 v66, v66, v78
    v_add_f32 v67, v67, v79
    v_add_f32 v64, v64, v80
    v_add_f32 v65, v65, v81
    v_add_f32 v66, v66, v82
    v_add_f32 v67, v67, v83
    v_add_f32 v64, v64, v84
    v_add_f32 v65, v65, v85
    v_add_f32 v66, v66, v86
    v_add_f32 v67, v67, v87
    v_add_f32 v64, v64, v88
    v_add_f32 v65, v65, v89
    v_add_f32 v66, v66, v90
    v_add_f32 v67, v67, v91
    v_add_f32 v64, v64, v92
    v_add_f32 v65, v65, v93
    v_add_f32 v66, v66, v94
    v_add_f32 v67, v67, v95
    v_mov_b32 v68, v64
    v_mov_b32 v69, v65
    v_mov_b32 v70, v66
    v_mov_b32 v71, v67
    v_permlane32_swap_b32 v64, v68
    v_permlane32_swap_b32 v65, v69
    v_permlane32_swap_b32 v66, v70
    v_permlane32_swap_b32 v67, v71
    v_add_f32 v64, v64, v68
    v_add_f32 v65, v65, v69
    v_add_f32 v66, v66, v70
    v_add_f32 v67, v67, v71
    v_and_b32 v68, 4, v9
    v_cmp_eq_u32 vcc, 0, v68
    v_mov_b32 v69, 3216550459
    s_nop 0
    v_cndmask_b32 v69, v69, 1.0, vcc
    v_mul_f32 v64, v64, v69
    v_mul_f32 v65, v65, v69
    v_add_u32 v10, 160768, v10
    ds_write_b128 v10, v[64:67]
    v_add_f32 v102, v102, v103
    v_add_f32 v104, v104, v105
    v_add_f32 v102, v102, v104
    v_cvt_pk_bf16_f32 v102, v102, v102
    v_and_b32 v102, v1, v102
    v_add_u32 v108, 159744, v108
    ds_write_b32 v108, v102
    s_waitcnt lgkmcnt(0)
    v_mov_b32 v42, 1
    s_mov_b64 exec, 1
    ds_add_u32 v41, v42 offset:24
    s_mov_b64 exec, -1
    s_branch L_g_h012
L_g_h3:
    s_waitcnt vmcnt(2)
    v_add_f32 v64, v64, v68
    v_add_f32 v65, v65, v69
    v_add_f32 v66, v66, v70
    v_add_f32 v67, v67, v71
    v_add_f32 v64, v64, v72
    v_add_f32 v65, v65, v73
    v_add_f32 v66, v66, v74
    v_add_f32 v67, v67, v75
    v_add_f32 v64, v64, v76
    v_add_f32 v65, v65, v77
    v_add_f32 v66, v66, v78
    v_add_f32 v67, v67, v79
    v_add_f32 v64, v64, v80
    v_add_f32 v65, v65, v81
    v_add_f32 v66, v66, v82
    v_add_f32 v67, v67, v83
    v_add_f32 v64, v64, v84
    v_add_f32 v65, v65, v85
    v_add_f32 v66, v66, v86
    v_add_f32 v67, v67, v87
    v_add_f32 v64, v64, v88
    v_add_f32 v65, v65, v89
    v_add_f32 v66, v66, v90
    v_add_f32 v67, v67, v91
    v_add_f32 v64, v64, v92
    v_add_f32 v65, v65, v93
    v_add_f32 v66, v66, v94
    v_add_f32 v67, v67, v95
    v_mov_b32 v68, v64
    v_mov_b32 v69, v65
    v_mov_b32 v70, v66
    v_mov_b32 v71, v67
    v_permlane32_swap_b32 v64, v68
    v_permlane32_swap_b32 v65, v69
    v_permlane32_swap_b32 v66, v70
    v_permlane32_swap_b32 v67, v71
    v_add_f32 v64, v64, v68
    v_add_f32 v65, v65, v69
    v_add_f32 v66, v66, v70
    v_add_f32 v67, v67, v71
    v_and_b32 v68, 4, v9
    v_cmp_eq_u32 vcc, 0, v68
    v_mov_b32 v69, 3216550459
    s_nop 0
    v_cndmask_b32 v69, v69, 1.0, vcc
    v_mul_f32 v64, v64, v69
    v_mul_f32 v65, v65, v69
    v_add_u32 v10, 160768, v10
    ds_write_b128 v10, v[64:67]
    v_add_f32 v102, v102, v103
    v_add_f32 v104, v104, v105
    v_add_f32 v102, v102, v104
    v_cvt_pk_bf16_f32 v102, v102, v102
    v_and_b32 v102, v1, v102
    v_add_u32 v108, 159744, v108
    ds_write_b32 v108, v102
    v_lshlrev_b32 v101, 3, v2
    v_add_u32 v101, 162816, v101
    s_lshl_b32 s38, s16, 11
    s_add_u32 s38, s38, 24346624
    v_lshl_add_u32 v100, v2, 4, s38
    s_mov_b32 s61, 0x40000
L_g_stp:
    s_sleep 3
    global_load_dwordx4 v[16:19], v100, s[4:5] sc1
    global_load_dwordx4 v[20:23], v100, s[4:5] offset:1024 sc1
    s_waitcnt vmcnt(0)
    v_xor_b32 v18, s60, v18
    v_xor_b32 v19, s60, v19
    v_xor_b32 v22, s60, v22
    v_xor_b32 v23, s60, v23
    v_or3_b32 v18, v18, v19, v22
    v_or_b32 v18, v18, v23
    v_cmp_ne_u32 vcc, 0, v18
    s_cbranch_vccz L_g_stok
    s_sub_u32 s61, s61, 1
    s_cbranch_scc0 L_g_stp
L_g_stok:
    ds_write_b64 v101, v[16:17]
    ds_write_b64 v101, v[20:21] offset:512
    s_waitcnt lgkmcnt(0)
    v_mov_b32 v42, 1
    s_mov_b64 exec, 1
    ds_add_u32 v41, v42 offset:24
    s_mov_b64 exec, -1
    s_add_u32 m0, s37, 73728
    s_add_u32 s23, s36, 0
    buffer_load_dwordx4 v12, s[44:47], s23 offen offset:0 sc1 lds
    buffer_load_dwordx4 v12, s[44:47], s23 offen offset:1024 sc1 lds
    buffer_load_dwordx4 v12, s[44:47], s23 offen offset:2048 sc1 lds
    buffer_load_dwordx4 v12, s[44:47], s23 offen offset:3072 sc1 lds
    s_add_u32 m0, s37, 77824
    s_add_u32 s23, s36, 4096
    buffer_load_dwordx4 v12, s[44:47], s23 offen offset:0 sc1 lds
    buffer_load_dwordx4 v12, s[44:47], s23 offen offset:1024 sc1 lds
    buffer_load_dwordx4 v12, s[44:47], s23 offen offset:2048 sc1 lds
L_g_h012:
    s_setprio 0
    s_add_u32 m0, s37, 102400
    s_add_u32 s23, s36, 57344
    buffer_load_dwordx4 v12, s[44:47], s23 offen offset:0 sc1 lds
    buffer_load_dwordx4 v12, s[44:47], s23 offen offset:1024 sc1 lds
    buffer_load_dwordx4 v12, s[44:47], s23 offen offset:2048 sc1 lds
    buffer_load_dwordx4 v12, s[44:47], s23 offen offset:3072 sc1 lds
    s_add_u32 m0, s37, 106496
    s_add_u32 s23, s36, 61440
    buffer_load_dwordx4 v12, s[44:47], s23 offen offset:0 sc1 lds
    buffer_load_dwordx4 v12, s[44:47], s23 offen offset:1024 sc1 lds
    buffer_load_dwordx4 v12, s[44:47], s23 offen offset:2048 sc1 lds
L_g_lt:
    ds_read_b32 v42, v41 offset:20
    s_waitcnt lgkmcnt(0)
    v_readfirstlane_b32 s38, v42
    s_nop 1
    s_cmp_lt_u32 s38, 4
    s_cbranch_scc1 L_g_lt
    s_add_u32 m0, s37, 0
    s_add_u32 s23, s36, 114688
    buffer_load_dwordx4 v12, s[44:47], s23 offen offset:0 sc1 lds
    buffer_load_dwordx4 v12, s[44:47], s23 offen offset:1024 sc1 lds
    buffer_load_dwordx4 v12, s[44:47], s23 offen offset:2048 sc1 lds
    buffer_load_dwordx4 v12, s[44:47], s23 offen offset:3072 sc1 lds
    s_add_u32 m0, s37, 4096
    s_add_u32 s23, s36, 118784
    buffer_load_dwordx4 v12, s[44:47], s23 offen offset:0 sc1 lds
    buffer_load_dwordx4 v12, s[44:47], s23 offen offset:1024 sc1 lds
    buffer_load_dwordx4 v12, s[44:47], s23 offen offset:2048 sc1 lds
L_g_lu:
    ds_read_b32 v42, v41 offset:28
    s_waitcnt lgkmcnt(0)
    v_readfirstlane_b32 s38, v42
    s_nop 1
    s_cmp_lt_u32 s38, 4
    s_cbranch_scc1 L_g_lu
    s_add_u32 m0, s37, 45056
    s_add_u32 s23, s36, 172032
    buffer_load_dwordx4 v12, s[44:47], s23 offen offset:0 sc1 lds
    buffer_load_dwordx4 v12, s[44:47], s23 offen offset:1024 sc1 lds
    buffer_load_dwordx4 v12, s[44:47], s23 offen offset:2048 sc1 lds
    buffer_load_dwordx4 v12, s[44:47], s23 offen offset:3072 sc1 lds
    s_add_u32 m0, s37, 49152
    s_add_u32 s23, s36, 176128
    buffer_load_dwordx4 v12, s[44:47], s23 offen offset:0 sc1 lds
    buffer_load_dwordx4 v12, s[44:47], s23 offen offset:1024 sc1 lds
    buffer_load_dwordx4 v12, s[44:47], s23 offen offset:2048 sc1 lds
L_g_join:
    s_mul_i32 s19, s50, 229376
    s_mul_i32 s18, s3, 7168
    s_add_u32 s19, s19, s18
    s_add_u32 s24, s19, 0
    s_add_u32 s25, s19, 57344
    s_add_u32 s26, s19, 114688
    s_add_u32 s27, s19, 172032
    s_lshr_b32 s21, s50, 1
    s_lshl_b32 s21, s21, 11
    s_lshl_b32 s22, s3, 8
    s_add_u32 s21, s21, s22
    s_add_u32 s21, s21, 24215552
    v_and_b32 v7, 1, v2
    v_lshl_add_u32 v7, v7, 7, s21
    v_mov_b32 v147, 0
    v_mov_b32 v151, 0
    v_mov_b32 v155, 0
    v_mov_b32 v159, 0
    v_mov_b32 v179, 0
    v_mov_b32 v183, 0
    v_mov_b32 v187, 0
    v_mov_b32 v191, 0
    v_mov_b32 v211, 0
    v_mov_b32 v215, 0
    v_mov_b32 v219, 0
    v_mov_b32 v223, 0
    v_mov_b32 v243, 0
    v_mov_b32 v247, 0
    v_mov_b32 v251, 0
    v_mov_b32 v255, 0
    v_mov_b32 v83, 0
    v_mov_b32 v87, 0
    v_mov_b32 v91, 0
    v_mov_b32 v95, 0
    v_mov_b32 v99, 0
    v_mov_b32 v103, 0
    v_mov_b32 v107, 0
    v_mov_b32 v111, 0
    v_mov_b32 v115, 0
    v_mov_b32 v119, 0
    v_mov_b32 v123, 0
    v_mov_b32 v127, 0
    v_mov_b32 v5, 160000
    s_cmp_lt_u32 s3, 4
    s_cbranch_scc1 L_g_x
    s_waitcnt vmcnt(0)
    v_mov_b32 v6, 1
    s_mov_b64 exec, 1
    ds_add_u32 v5, v6 offset:8
    s_mov_b64 exec, -1
L_g_h:
    s_sleep 2
    ds_read_b32 v6, v5 offset:0
    s_waitcnt lgkmcnt(0)
    v_readfirstlane_b32 s22, v6
    s_nop 1
    s_cmp_lt_u32 s22, 4
    s_cbranch_scc1 L_g_h
    s_branch L_g_y
L_g_x:
L_g_w:
    ds_read_b32 v6, v5 offset:8
    s_waitcnt lgkmcnt(0)
    v_readfirstlane_b32 s22, v6
    s_nop 1
    s_cmp_lt_u32 s22, 4
    s_cbranch_scc1 L_g_w
    s_mul_i32 s21, s3, 7168
    v_add_u32 v10, s21, v12
    v_add_u32 v11, s21, v15
    v_add_u32 v13, 73728, v10
    v_add_u32 v14, 73728, v11
    ds_read_b128 v[128:131], v13 offset:0
    ds_read_b128 v[132:135], v13 offset:28672
    ds_read_b128 v[136:139], v10 offset:0
    ds_read_b128 v[140:143], v10 offset:45056
    ds_read_b32 v144, v14 offset:1024
    ds_read_b32 v145, v14 offset:1028
    ds_read_b32 v146, v14 offset:1032
    ds_read_b32 v148, v14 offset:29696
    ds_read_b32 v149, v14 offset:29700
    ds_read_b32 v150, v14 offset:29704
    ds_read_b32 v152, v11 offset:1024
    ds_read_b32 v153, v11 offset:1028
    ds_read_b32 v154, v11 offset:1032
    ds_read_b32 v156, v11 offset:46080
    ds_read_b32 v157, v11 offset:46084
    ds_read_b32 v158, v11 offset:46088
    ds_read_b128 v[160:163], v13 offset:1792
    ds_read_b128 v[164:167], v13 offset:30464
    ds_read_b128 v[168:171], v10 offset:1792
    ds_read_b128 v[172:175], v10 offset:46848
    ds_read_b32 v176, v14 offset:2816
    ds_read_b32 v177, v14 offset:2820
    ds_read_b32 v178, v14 offset:2824
    ds_read_b32 v180, v14 offset:31488
    ds_read_b32 v181, v14 offset:31492
    ds_read_b32 v182, v14 offset:31496
    ds_read_b32 v184, v11 offset:2816
    ds_read_b32 v185, v11 offset:2820
    ds_read_b32 v186, v11 offset:2824
    ds_read_b32 v188, v11 offset:47872
    ds_read_b32 v189, v11 offset:47876
    ds_read_b32 v190, v11 offset:47880
    ds_read_b128 v[192:195], v13 offset:3584
    ds_read_b128 v[196:199], v13 offset:32256
    ds_read_b128 v[200:203], v10 offset:3584
    ds_read_b128 v[204:207], v10 offset:48640
    ds_read_b32 v208, v14 offset:4608
    ds_read_b32 v209, v14 offset:4612
    ds_read_b32 v210, v14 offset:4616
    ds_read_b32 v212, v14 offset:33280
    ds_read_b32 v213, v14 offset:33284
    ds_read_b32 v214, v14 offset:33288
    ds_read_b32 v216, v11 offset:4608
    ds_read_b32 v217, v11 offset:4612
    ds_read_b32 v218, v11 offset:4616
    ds_read_b32 v220, v11 offset:49664
    ds_read_b32 v221, v11 offset:49668
    ds_read_b32 v222, v11 offset:49672
    ds_read_b128 v[224:227], v13 offset:5376
    ds_read_b128 v[228:231], v13 offset:34048
    ds_read_b128 v[232:235], v10 offset:5376
    ds_read_b128 v[236:239], v10 offset:50432
    ds_read_b32 v240, v14 offset:6400
    ds_read_b32 v241, v14 offset:6404
    ds_read_b32 v242, v14 offset:6408
    ds_read_b32 v244, v14 offset:35072
    ds_read_b32 v245, v14 offset:35076
    ds_read_b32 v246, v14 offset:35080
    ds_read_b32 v248, v11 offset:6400
    ds_read_b32 v249, v11 offset:6404
    ds_read_b32 v250, v11 offset:6408
    ds_read_b32 v252, v11 offset:51456
    ds_read_b32 v253, v11 offset:51460
    ds_read_b32 v254, v11 offset:51464
    v_mov_b32 v13, v7
    v_mov_b32 v6, 1
    s_waitcnt vmcnt(0)
    s_mov_b64 exec, 1
    ds_add_rtn_u32 v6, v5, v6 offset:0
    s_mov_b64 exec, -1
    s_waitcnt lgkmcnt(0)
    v_readfirstlane_b32 s22, v6
    s_nop 1
    s_cmp_lg_u32 s22, 3
    s_cbranch_scc1 L_g_arrb
    v_lshl_add_u32 v7, v2, 2, s31
    s_mov_b64 exec, 0xffffffff
    global_store_dword v7, v8, s[4:5] sc1
    s_mov_b64 exec, -1
L_g_arrb:
    v_mov_b32 v7, v13
    v_mov_b32 v6, 1
    s_mov_b64 exec, 1
    ds_add_u32 v5, v6 offset:12
    s_mov_b64 exec, -1
L_g_y:
    s_mov_b32 s61, 0x40000
    v_add_u32 v11, 0, v7
    v_mov_b32 v14, v7
L_g_poll:
    global_load_dword v9, v11, s[4:5] sc1
    s_waitcnt vmcnt(0)
    v_cmp_ne_u32 vcc, s60, v9
    s_cbranch_vccz L_g_go
    s_sleep 2
    s_sub_u32 s61, s61, 1
    s_cbranch_scc0 L_g_poll
L_g_go:
    buffer_load_dwordx4 v[80:83], v12, s[8:11], s24 offen offset:0 sc1
    buffer_load_dwordx3 v[84:86], v15, s[8:11], s24 offen offset:1024 sc1
    buffer_load_dwordx4 v[88:91], v12, s[8:11], s24 offen offset:1792 sc1
    buffer_load_dwordx3 v[92:94], v15, s[8:11], s24 offen offset:2816 sc1
    buffer_load_dwordx4 v[96:99], v12, s[8:11], s24 offen offset:3584 sc1
    s_add_u32 s30, s24, 4096
    buffer_load_dwordx3 v[100:102], v15, s[8:11], s30 offen offset:512 sc1
    s_add_u32 s30, s24, 4096
    buffer_load_dwordx4 v[104:107], v12, s[8:11], s30 offen offset:1280 sc1
    s_add_u32 s30, s24, 4096
    buffer_load_dwordx3 v[108:110], v15, s[8:11], s30 offen offset:2304 sc1
    s_mov_b32 s40, s6
    s_mov_b32 s41, s7
    s_mov_b32 s42, 2097152
    s_mov_b32 s43, 0x20000
    s_lshr_b32 s18, s3, 2
    s_and_b32 s19, s3, 3
    s_lshl_b32 s20, s51, 1
    s_add_u32 s20, s20, s18
    s_lshl_b32 s21, s50, 2
    s_add_u32 s21, s21, s19
    v_lshlrev_b32 v10, 10, v3
    v_lshl_add_u32 v10, v4, 4, v10
    s_lshl_b32 s28, s21, 14
    s_lshl_b32 s29, s20, 6
    s_add_u32 s28, s28, s29
    v_bfe_u32 v6, v2, 2, 2
    v_lshl_add_u32 v6, v4, 3, v6
    v_and_b32 v7, 3, v2
    v_lshlrev_b32 v7, 3, v7
    v_lshl_add_u32 v6, v6, 7, v7
    s_lshl_b32 s22, s18, 12
    s_lshl_b32 s23, s19, 5
    s_add_u32 s22, s22, s23
    s_add_u32 s22, s22, 151552
    v_add_u32 v6, s22, v6
    s_lshl_b32 s22, s18, 7
    s_add_u32 s22, s22, 159744
    v_lshl_add_u32 v7, v4, 5, s22
    v_mov_b32 v5, 160000
    v_mov_b32 v13, v6
    s_lshl_b32 s29, s3, 11
    s_lshl_b32 s30, s18, 16
    s_add_u32 s29, s29, s30
    v_add_u32 v9, s29, v12
    v_xor_b32 v11, 0x10000, v9
L_g_r:
    ds_read_b32 v6, v5 offset:12
    s_waitcnt lgkmcnt(0)
    v_readfirstlane_b32 s22, v6
    s_nop 1
    s_cmp_lt_u32 s22, 4
    s_cbranch_scc1 L_g_r
    s_waitcnt vmcnt(7)
    v_mfma_f32_16x16x32_bf16 v[16:19], v[128:131], v[80:83], 0
    v_mfma_f32_16x16x32_bf16 v[20:23], v[132:135], v[80:83], 0
    v_mfma_f32_16x16x32_bf16 v[24:27], v[136:139], v[80:83], 0
    v_mfma_f32_16x16x32_bf16 v[28:31], v[140:143], v[80:83], 0
    buffer_load_dwordx4 v[80:83], v12, s[8:11], s25 offen offset:0 sc1
    s_waitcnt vmcnt(7)
    v_mfma_f32_16x16x32_bf16 v[16:19], v[144:147], v[84:87], v[16:19]
    v_mfma_f32_16x16x32_bf16 v[20:23], v[148:151], v[84:87], v[20:23]
    v_mfma_f32_16x16x32_bf16 v[24:27], v[152:155], v[84:87], v[24:27]
    v_mfma_f32_16x16x32_bf16 v[28:31], v[156:159], v[84:87], v[28:31]
    buffer_load_dwordx3 v[84:86], v15, s[8:11], s25 offen offset:1024 sc1
    s_waitcnt vmcnt(7)
    v_mfma_f32_16x16x32_bf16 v[16:19], v[160:163], v[88:91], v[16:19]
    v_mfma_f32_16x16x32_bf16 v[20:23], v[164:167], v[88:91], v[20:23]
    v_mfma_f32_16x16x32_bf16 v[24:27], v[168:171], v[88:91], v[24:27]
    v_mfma_f32_16x16x32_bf16 v[28:31], v[172:175], v[88:91], v[28:31]
    buffer_load_dwordx4 v[88:91], v12, s[8:11], s25 offen offset:1792 sc1
    s_waitcnt vmcnt(7)
    v_mfma_f32_16x16x32_bf16 v[16:19], v[176:179], v[92:95], v[16:19]
    v_mfma_f32_16x16x32_bf16 v[20:23], v[180:183], v[92:95], v[20:23]
    v_mfma_f32_16x16x32_bf16 v[24:27], v[184:187], v[92:95], v[24:27]
    v_mfma_f32_16x16x32_bf16 v[28:31], v[188:191], v[92:95], v[28:31]
    buffer_load_dwordx3 v[92:94], v15, s[8:11], s25 offen offset:2816 sc1
    s_waitcnt vmcnt(7)
    v_mfma_f32_16x16x32_bf16 v[16:19], v[192:195], v[96:99], v[16:19]
    v_mfma_f32_16x16x32_bf16 v[20:23], v[196:199], v[96:99], v[20:23]
    v_mfma_f32_16x16x32_bf16 v[24:27], v[200:203], v[96:99], v[24:27]
    v_mfma_f32_16x16x32_bf16 v[28:31], v[204:207], v[96:99], v[28:31]
    buffer_load_dwordx4 v[96:99], v12, s[8:11], s25 offen offset:3584 sc1
    s_waitcnt vmcnt(7)
    v_mfma_f32_16x16x32_bf16 v[16:19], v[208:211], v[100:103], v[16:19]
    v_mfma_f32_16x16x32_bf16 v[20:23], v[212:215], v[100:103], v[20:23]
    v_mfma_f32_16x16x32_bf16 v[24:27], v[216:219], v[100:103], v[24:27]
    v_mfma_f32_16x16x32_bf16 v[28:31], v[220:223], v[100:103], v[28:31]
    s_add_u32 s30, s25, 4096
    buffer_load_dwordx3 v[100:102], v15, s[8:11], s30 offen offset:512 sc1
    s_waitcnt vmcnt(7)
    v_mfma_f32_16x16x32_bf16 v[16:19], v[224:227], v[104:107], v[16:19]
    v_mfma_f32_16x16x32_bf16 v[20:23], v[228:231], v[104:107], v[20:23]
    v_mfma_f32_16x16x32_bf16 v[24:27], v[232:235], v[104:107], v[24:27]
    v_mfma_f32_16x16x32_bf16 v[28:31], v[236:239], v[104:107], v[28:31]
    s_add_u32 s30, s25, 4096
    buffer_load_dwordx4 v[104:107], v12, s[8:11], s30 offen offset:1280 sc1
    s_waitcnt vmcnt(7)
    v_mfma_f32_16x16x32_bf16 v[16:19], v[240:243], v[108:111], v[16:19]
    v_mfma_f32_16x16x32_bf16 v[20:23], v[244:247], v[108:111], v[20:23]
    v_mfma_f32_16x16x32_bf16 v[24:27], v[248:251], v[108:111], v[24:27]
    v_mfma_f32_16x16x32_bf16 v[28:31], v[252:255], v[108:111], v[28:31]
    s_add_u32 s30, s25, 4096
    buffer_load_dwordx3 v[108:110], v15, s[8:11], s30 offen offset:2304 sc1
    s_waitcnt vmcnt(7)
    v_mfma_f32_16x16x32_bf16 v[32:35], v[128:131], v[80:83], 0
    v_mfma_f32_16x16x32_bf16 v[36:39], v[132:135], v[80:83], 0
    v_mfma_f32_16x16x32_bf16 v[40:43], v[136:139], v[80:83], 0
    v_mfma_f32_16x16x32_bf16 v[44:47], v[140:143], v[80:83], 0
    buffer_load_dwordx4 v[80:83], v12, s[8:11], s26 offen offset:0 sc1
    s_waitcnt vmcnt(7)
    v_mfma_f32_16x16x32_bf16 v[32:35], v[144:147], v[84:87], v[32:35]
    v_mfma_f32_16x16x32_bf16 v[36:39], v[148:151], v[84:87], v[36:39]
    v_mfma_f32_16x16x32_bf16 v[40:43], v[152:155], v[84:87], v[40:43]
    v_mfma_f32_16x16x32_bf16 v[44:47], v[156:159], v[84:87], v[44:47]
    buffer_load_dwordx3 v[84:86], v15, s[8:11], s26 offen offset:1024 sc1
    ds_write_b128 v9, v[16:19] offset:0
    ds_write_b128 v9, v[20:23] offset:1024
    ds_write_b128 v11, v[24:27] offset:0
    ds_write_b128 v11, v[28:31] offset:1024
    s_waitcnt vmcnt(7)
    v_mfma_f32_16x16x32_bf16 v[32:35], v[160:163], v[88:91], v[32:35]
    v_mfma_f32_16x16x32_bf16 v[36:39], v[164:167], v[88:91], v[36:39]
    v_mfma_f32_16x16x32_bf16 v[40:43], v[168:171], v[88:91], v[40:43]
    v_mfma_f32_16x16x32_bf16 v[44:47], v[172:175], v[88:91], v[44:47]
    buffer_load_dwordx4 v[88:91], v12, s[8:11], s26 offen offset:1792 sc1
    s_waitcnt vmcnt(7)
    v_mfma_f32_16x16x32_bf16 v[32:35], v[176:179], v[92:95], v[32:35]
    v_mfma_f32_16x16x32_bf16 v[36:39], v[180:183], v[92:95], v[36:39]
    v_mfma_f32_16x16x32_bf16 v[40:43], v[184:187], v[92:95], v[40:43]
    v_mfma_f32_16x16x32_bf16 v[44:47], v[188:191], v[92:95], v[44:47]
    buffer_load_dwordx3 v[92:94], v15, s[8:11], s26 offen offset:2816 sc1
    s_waitcnt vmcnt(7)
    v_mfma_f32_16x16x32_bf16 v[32:35], v[192:195], v[96:99], v[32:35]
    v_mfma_f32_16x16x32_bf16 v[36:39], v[196:199], v[96:99], v[36:39]
    v_mfma_f32_16x16x32_bf16 v[40:43], v[200:203], v[96:99], v[40:43]
    v_mfma_f32_16x16x32_bf16 v[44:47], v[204:207], v[96:99], v[44:47]
    buffer_load_dwordx4 v[96:99], v12, s[8:11], s26 offen offset:3584 sc1
    s_waitcnt vmcnt(7)
    v_mfma_f32_16x16x32_bf16 v[32:35], v[208:211], v[100:103], v[32:35]
    v_mfma_f32_16x16x32_bf16 v[36:39], v[212:215], v[100:103], v[36:39]
    v_mfma_f32_16x16x32_bf16 v[40:43], v[216:219], v[100:103], v[40:43]
    v_mfma_f32_16x16x32_bf16 v[44:47], v[220:223], v[100:103], v[44:47]
    s_add_u32 s30, s26, 4096
    buffer_load_dwordx3 v[100:102], v15, s[8:11], s30 offen offset:512 sc1
    s_waitcnt vmcnt(7)
    v_mfma_f32_16x16x32_bf16 v[32:35], v[224:227], v[104:107], v[32:35]
    v_mfma_f32_16x16x32_bf16 v[36:39], v[228:231], v[104:107], v[36:39]
    v_mfma_f32_16x16x32_bf16 v[40:43], v[232:235], v[104:107], v[40:43]
    v_mfma_f32_16x16x32_bf16 v[44:47], v[236:239], v[104:107], v[44:47]
    s_add_u32 s30, s26, 4096
    buffer_load_dwordx4 v[104:107], v12, s[8:11], s30 offen offset:1280 sc1
    s_waitcnt vmcnt(7)
    v_mfma_f32_16x16x32_bf16 v[32:35], v[240:243], v[108:111], v[32:35]
    v_mfma_f32_16x16x32_bf16 v[36:39], v[244:247], v[108:111], v[36:39]
    v_mfma_f32_16x16x32_bf16 v[40:43], v[248:251], v[108:111], v[40:43]
    v_mfma_f32_16x16x32_bf16 v[44:47], v[252:255], v[108:111], v[44:47]
    s_add_u32 s30, s26, 4096
    buffer_load_dwordx3 v[108:110], v15, s[8:11], s30 offen offset:2304 sc1
    s_waitcnt vmcnt(7)
    v_mfma_f32_16x16x32_bf16 v[48:51], v[128:131], v[80:83], 0
    v_mfma_f32_16x16x32_bf16 v[52:55], v[132:135], v[80:83], 0
    v_mfma_f32_16x16x32_bf16 v[56:59], v[136:139], v[80:83], 0
    v_mfma_f32_16x16x32_bf16 v[60:63], v[140:143], v[80:83], 0
    buffer_load_dwordx4 v[80:83], v12, s[8:11], s27 offen offset:0 sc1
    s_waitcnt vmcnt(7)
    v_mfma_f32_16x16x32_bf16 v[48:51], v[144:147], v[84:87], v[48:51]
    v_mfma_f32_16x16x32_bf16 v[52:55], v[148:151], v[84:87], v[52:55]
    v_mfma_f32_16x16x32_bf16 v[56:59], v[152:155], v[84:87], v[56:59]
    v_mfma_f32_16x16x32_bf16 v[60:63], v[156:159], v[84:87], v[60:63]
    buffer_load_dwordx3 v[84:86], v15, s[8:11], s27 offen offset:1024 sc1
    ds_write_b128 v9, v[32:35] offset:16384
    ds_write_b128 v9, v[36:39] offset:17408
    ds_write_b128 v11, v[40:43] offset:16384
    ds_write_b128 v11, v[44:47] offset:17408
    s_waitcnt vmcnt(7)
    v_mfma_f32_16x16x32_bf16 v[48:51], v[160:163], v[88:91], v[48:51]
    v_mfma_f32_16x16x32_bf16 v[52:55], v[164:167], v[88:91], v[52:55]
    v_mfma_f32_16x16x32_bf16 v[56:59], v[168:171], v[88:91], v[56:59]
    v_mfma_f32_16x16x32_bf16 v[60:63], v[172:175], v[88:91], v[60:63]
    buffer_load_dwordx4 v[88:91], v12, s[8:11], s27 offen offset:1792 sc1
    s_waitcnt vmcnt(7)
    v_mfma_f32_16x16x32_bf16 v[48:51], v[176:179], v[92:95], v[48:51]
    v_mfma_f32_16x16x32_bf16 v[52:55], v[180:183], v[92:95], v[52:55]
    v_mfma_f32_16x16x32_bf16 v[56:59], v[184:187], v[92:95], v[56:59]
    v_mfma_f32_16x16x32_bf16 v[60:63], v[188:191], v[92:95], v[60:63]
    buffer_load_dwordx3 v[92:94], v15, s[8:11], s27 offen offset:2816 sc1
    s_waitcnt vmcnt(7)
    v_mfma_f32_16x16x32_bf16 v[48:51], v[192:195], v[96:99], v[48:51]
    v_mfma_f32_16x16x32_bf16 v[52:55], v[196:199], v[96:99], v[52:55]
    v_mfma_f32_16x16x32_bf16 v[56:59], v[200:203], v[96:99], v[56:59]
    v_mfma_f32_16x16x32_bf16 v[60:63], v[204:207], v[96:99], v[60:63]
    buffer_load_dwordx4 v[96:99], v12, s[8:11], s27 offen offset:3584 sc1
    s_waitcnt vmcnt(7)
    v_mfma_f32_16x16x32_bf16 v[48:51], v[208:211], v[100:103], v[48:51]
    v_mfma_f32_16x16x32_bf16 v[52:55], v[212:215], v[100:103], v[52:55]
    v_mfma_f32_16x16x32_bf16 v[56:59], v[216:219], v[100:103], v[56:59]
    v_mfma_f32_16x16x32_bf16 v[60:63], v[220:223], v[100:103], v[60:63]
    s_add_u32 s30, s27, 4096
    buffer_load_dwordx3 v[100:102], v15, s[8:11], s30 offen offset:512 sc1
    s_waitcnt vmcnt(7)
    v_mfma_f32_16x16x32_bf16 v[48:51], v[224:227], v[104:107], v[48:51]
    v_mfma_f32_16x16x32_bf16 v[52:55], v[228:231], v[104:107], v[52:55]
    v_mfma_f32_16x16x32_bf16 v[56:59], v[232:235], v[104:107], v[56:59]
    v_mfma_f32_16x16x32_bf16 v[60:63], v[236:239], v[104:107], v[60:63]
    s_add_u32 s30, s27, 4096
    buffer_load_dwordx4 v[104:107], v12, s[8:11], s30 offen offset:1280 sc1
    s_waitcnt vmcnt(7)
    v_mfma_f32_16x16x32_bf16 v[48:51], v[240:243], v[108:111], v[48:51]
    v_mfma_f32_16x16x32_bf16 v[52:55], v[244:247], v[108:111], v[52:55]
    v_mfma_f32_16x16x32_bf16 v[56:59], v[248:251], v[108:111], v[56:59]
    v_mfma_f32_16x16x32_bf16 v[60:63], v[252:255], v[108:111], v[60:63]
    s_add_u32 s30, s27, 4096
    buffer_load_dwordx3 v[108:110], v15, s[8:11], s30 offen offset:2304 sc1
    s_waitcnt vmcnt(7)
    v_mfma_f32_16x16x32_bf16 v[64:67], v[128:131], v[80:83], 0
    v_mfma_f32_16x16x32_bf16 v[68:71], v[132:135], v[80:83], 0
    v_mfma_f32_16x16x32_bf16 v[72:75], v[136:139], v[80:83], 0
    v_mfma_f32_16x16x32_bf16 v[76:79], v[140:143], v[80:83], 0
    s_waitcnt vmcnt(6)
    v_mfma_f32_16x16x32_bf16 v[64:67], v[144:147], v[84:87], v[64:67]
    v_mfma_f32_16x16x32_bf16 v[68:71], v[148:151], v[84:87], v[68:71]
    v_mfma_f32_16x16x32_bf16 v[72:75], v[152:155], v[84:87], v[72:75]
    v_mfma_f32_16x16x32_bf16 v[76:79], v[156:159], v[84:87], v[76:79]
    ds_write_b128 v9, v[48:51] offset:32768
    ds_write_b128 v9, v[52:55] offset:33792
    ds_write_b128 v11, v[56:59] offset:32768
    ds_write_b128 v11, v[60:63] offset:33792
    s_waitcnt vmcnt(5)
    v_mfma_f32_16x16x32_bf16 v[64:67], v[160:163], v[88:91], v[64:67]
    v_mfma_f32_16x16x32_bf16 v[68:71], v[164:167], v[88:91], v[68:71]
    v_mfma_f32_16x16x32_bf16 v[72:75], v[168:171], v[88:91], v[72:75]
    v_mfma_f32_16x16x32_bf16 v[76:79], v[172:175], v[88:91], v[76:79]
    s_waitcnt vmcnt(4)
    v_mfma_f32_16x16x32_bf16 v[64:67], v[176:179], v[92:95], v[64:67]
    v_mfma_f32_16x16x32_bf16 v[68:71], v[180:183], v[92:95], v[68:71]
    v_mfma_f32_16x16x32_bf16 v[72:75], v[184:187], v[92:95], v[72:75]
    v_mfma_f32_16x16x32_bf16 v[76:79], v[188:191], v[92:95], v[76:79]
    s_waitcnt lgkmcnt(0)
    ds_read_b64_tr_b16 v[24:25], v13
    ds_read_b64_tr_b16 v[26:27], v13 offset:512
    ds_read_b128 v[32:35], v7
    ds_read_b128 v[36:39], v7 offset:16
    s_waitcnt vmcnt(3)
    v_mfma_f32_16x16x32_bf16 v[64:67], v[192:195], v[96:99], v[64:67]
    v_mfma_f32_16x16x32_bf16 v[68:71], v[196:199], v[96:99], v[68:71]
    v_mfma_f32_16x16x32_bf16 v[72:75], v[200:203], v[96:99], v[72:75]
    v_mfma_f32_16x16x32_bf16 v[76:79], v[204:207], v[96:99], v[76:79]
    s_waitcnt vmcnt(2)
    v_mfma_f32_16x16x32_bf16 v[64:67], v[208:211], v[100:103], v[64:67]
    v_mfma_f32_16x16x32_bf16 v[68:71], v[212:215], v[100:103], v[68:71]
    v_mfma_f32_16x16x32_bf16 v[72:75], v[216:219], v[100:103], v[72:75]
    v_mfma_f32_16x16x32_bf16 v[76:79], v[220:223], v[100:103], v[76:79]
    s_waitcnt lgkmcnt(0)
    v_lshlrev_b32 v16, 16, v24
    v_and_b32 v17, v1, v24
    v_lshlrev_b32 v18, 16, v25
    v_and_b32 v19, v1, v25
    v_lshlrev_b32 v20, 16, v26
    v_and_b32 v21, v1, v26
    v_lshlrev_b32 v22, 16, v27
    v_and_b32 v23, v1, v27
    s_waitcnt vmcnt(1)
    v_mfma_f32_16x16x32_bf16 v[64:67], v[224:227], v[104:107], v[64:67]
    v_mfma_f32_16x16x32_bf16 v[68:71], v[228:231], v[104:107], v[68:71]
    v_mfma_f32_16x16x32_bf16 v[72:75], v[232:235], v[104:107], v[72:75]
    v_mfma_f32_16x16x32_bf16 v[76:79], v[236:239], v[104:107], v[76:79]
    s_waitcnt vmcnt(0)
    v_mfma_f32_16x16x32_bf16 v[64:67], v[240:243], v[108:111], v[64:67]
    v_mfma_f32_16x16x32_bf16 v[68:71], v[244:247], v[108:111], v[68:71]
    v_mfma_f32_16x16x32_bf16 v[72:75], v[248:251], v[108:111], v[72:75]
    v_mfma_f32_16x16x32_bf16 v[76:79], v[252:255], v[108:111], v[76:79]
    s_nop 4
    ds_write_b128 v9, v[64:67] offset:49152
    ds_write_b128 v9, v[68:71] offset:50176
    ds_write_b128 v11, v[72:75] offset:49152
    ds_write_b128 v11, v[76:79] offset:50176
    s_lshl_b32 s29, s3, 14
    v_add_u32 v9, s29, v12
    s_waitcnt lgkmcnt(0)
    s_barrier
    ds_read_b128 v[192:195], v9 offset:0
    ds_read_b128 v[196:199], v9 offset:1024
    ds_read_b128 v[200:203], v9 offset:2048
    ds_read_b128 v[204:207], v9 offset:3072
    ds_read_b128 v[208:211], v9 offset:4096
    ds_read_b128 v[212:215], v9 offset:5120
    ds_read_b128 v[216:219], v9 offset:6144
    ds_read_b128 v[220:223], v9 offset:7168
    ds_read_b128 v[224:227], v9 offset:8192
    ds_read_b128 v[228:231], v9 offset:9216
    ds_read_b128 v[232:235], v9 offset:10240
    ds_read_b128 v[236:239], v9 offset:11264
    ds_read_b128 v[240:243], v9 offset:12288
    ds_read_b128 v[244:247], v9 offset:13312
    ds_read_b128 v[248:251], v9 offset:14336
    ds_read_b128 v[252:255], v9 offset:15360
    s_waitcnt lgkmcnt(12)
    v_pk_add_f32 v[192:193], v[192:193], v[200:201]
    v_pk_add_f32 v[194:195], v[194:195], v[202:203]
    v_pk_add_f32 v[196:197], v[196:197], v[204:205]
    v_pk_add_f32 v[198:199], v[198:199], v[206:207]
    s_waitcnt lgkmcnt(10)
    v_pk_add_f32 v[192:193], v[192:193], v[208:209]
    v_pk_add_f32 v[194:195], v[194:195], v[210:211]
    v_pk_add_f32 v[196:197], v[196:197], v[212:213]
    v_pk_add_f32 v[198:199], v[198:199], v[214:215]
    s_waitcnt lgkmcnt(8)
    v_pk_add_f32 v[192:193], v[192:193], v[216:217]
    v_pk_add_f32 v[194:195], v[194:195], v[218:219]
    v_pk_add_f32 v[196:197], v[196:197], v[220:221]
    v_pk_add_f32 v[198:199], v[198:199], v[222:223]
    s_waitcnt lgkmcnt(6)
    v_pk_add_f32 v[192:193], v[192:193], v[224:225]
    v_pk_add_f32 v[194:195], v[194:195], v[226:227]
    v_pk_add_f32 v[196:197], v[196:197], v[228:229]
    v_pk_add_f32 v[198:199], v[198:199], v[230:231]
    s_waitcnt lgkmcnt(4)
    v_pk_add_f32 v[192:193], v[192:193], v[232:233]
    v_pk_add_f32 v[194:195], v[194:195], v[234:235]
    v_pk_add_f32 v[196:197], v[196:197], v[236:237]
    v_pk_add_f32 v[198:199], v[198:199], v[238:239]
    s_waitcnt lgkmcnt(2)
    v_pk_add_f32 v[192:193], v[192:193], v[240:241]
    v_pk_add_f32 v[194:195], v[194:195], v[242:243]
    v_pk_add_f32 v[196:197], v[196:197], v[244:245]
    v_pk_add_f32 v[198:199], v[198:199], v[246:247]
    s_waitcnt lgkmcnt(0)
    v_pk_add_f32 v[192:193], v[192:193], v[248:249]
    v_pk_add_f32 v[194:195], v[194:195], v[250:251]
    v_pk_add_f32 v[196:197], v[196:197], v[252:253]
    v_pk_add_f32 v[198:199], v[198:199], v[254:255]
    v_pk_fma_f32 v[16:17], v[192:193], v[32:33], v[16:17]
    v_pk_fma_f32 v[18:19], v[194:195], v[34:35], v[18:19]
    v_pk_fma_f32 v[20:21], v[196:197], v[36:37], v[20:21]
    v_pk_fma_f32 v[22:23], v[198:199], v[38:39], v[22:23]
    v_cvt_pk_bf16_f32 v80, v16, v17
    v_cvt_pk_bf16_f32 v81, v18, v19
    v_cvt_pk_bf16_f32 v82, v20, v21
    v_cvt_pk_bf16_f32 v83, v22, v23
    buffer_store_dwordx4 v[80:83], v10, s[40:43], s28 offen sc1
L_end:
    s_endpgm
.section .rodata,"a"
.p2align 6
.amdhsa_kernel adaLN_cond__ssm_conv_s4__glu_gated_glu__prompt_kernel
  .amdhsa_next_free_vgpr 256
  .amdhsa_next_free_sgpr 72
  .amdhsa_accum_offset 256
  .amdhsa_group_segment_fixed_size 0
  .amdhsa_kernarg_size 144
  .amdhsa_user_sgpr_count 2
  .amdhsa_user_sgpr_kernarg_segment_ptr 1
  .amdhsa_system_sgpr_workgroup_id_x 1
  .amdhsa_float_denorm_mode_32 3
  .amdhsa_float_denorm_mode_16_64 3
.end_amdhsa_kernel
```
